```python
import torch

def _softmax(x, axis=-1):
    return torch.softmax(x, dim=axis)
def _gelu(x):
    return torch.nn.functional.gelu(x, approximate="tanh")
def _silu(x):
    return torch.nn.functional.silu(x)
def _sigmoid(x):
    return torch.sigmoid(x)
def _layernorm(x, axis=-1, eps=1e-5):
    m = x.mean(dim=axis, keepdim=True)
    v = x.var(dim=axis, keepdim=True, unbiased=False)
    return (x - m) / torch.sqrt(v + eps)
def _scatter_add(tgt, idx, src, axis=0):
    return tgt.clone().index_add_(axis, idx, src)
def _segment_sum(src, seg, n):
    out = torch.zeros((n,) + src.shape[1:], dtype=src.dtype)
    return out.index_add_(0, seg, src)
def _pad(x, pw):
    flat = tuple(v for pair in reversed(pw) for v in pair)
    return torch.nn.functional.pad(x, flat)

kernel_name = 'gated_mix__ssm_conv_s4d__ssm_conv_h3__prompt'

def setup_inputs():

    _w = (lambda a: (lambda t: t.to(torch.bfloat16) if t.is_floating_point() else t)(torch.as_tensor(a)))
    def _A_setup():
        Bsz, L, D, N = 1, 2048, 1024, 128
        return {
            "u": _w((lambda *s: torch.randn(*s, dtype=torch.bfloat16) * 0.05)(Bsz, L, D)),
            "log_A_real": _w((lambda *s: torch.randn(*s, dtype=torch.bfloat16) * 3.2)(D, N) * 0.5),
            "A_imag": _w((lambda *s: torch.randn(*s, dtype=torch.bfloat16) * 0.05)(D, N) * 3.14),
            "C_real": _w((lambda *s: torch.randn(*s, dtype=torch.bfloat16) * 0.1)(D, N) / N ** 0.5),
            "C_imag": _w((lambda *s: torch.randn(*s, dtype=torch.bfloat16) * 0.1)(D, N) / N ** 0.5),
            "log_dt": _w((lambda *s: torch.randn(*s, dtype=torch.bfloat16) * 0.05)(D) * 0.5 - 4.0),
            "D_skip": _w((lambda *s: torch.randn(*s, dtype=torch.bfloat16) * 0.05)(D)),
        }
    _A_in = _A_setup()

    def _B_setup():
        B, S, D = 1, 2048, 1024
        ks = 4
        return {
            "q": _w((lambda *s: torch.randn(*s, dtype=torch.bfloat16) * 0.05)(B, S, D)),
            "k": _w((lambda *s: torch.randn(*s, dtype=torch.bfloat16) * 0.4)(B, S, D)),
            "v": _w((lambda *s: torch.randn(*s, dtype=torch.bfloat16) * 0.2)(B, S, D)),
            "shift_k": _w((lambda *s: torch.randn(*s, dtype=torch.bfloat16) * 0.4)(D, ks) * 0.5),
            "ssm_k": _w((lambda *s: torch.randn(*s, dtype=torch.bfloat16) * 0.4)(D, S) * (1.0 / S ** 0.5)),
            "ssm_D": _w((lambda *s: torch.randn(*s, dtype=torch.bfloat16) * 0.4)(D)),
        }
    _B_in = _B_setup()

    return {
        "A_u": _A_in["u"],
        "A_log_A_real": _A_in["log_A_real"],
        "A_A_imag": _A_in["A_imag"],
        "A_C_real": _A_in["C_real"],
        "A_C_imag": _A_in["C_imag"],
        "A_log_dt": _A_in["log_dt"],
        "A_D_skip": _A_in["D_skip"],
        "B_q": _B_in["q"],
        "B_k": _B_in["k"],
        "B_v": _B_in["v"],
        "B_shift_k": _B_in["shift_k"],
        "B_ssm_k": _B_in["ssm_k"],
        "B_ssm_D": _B_in["ssm_D"],
        "gate_w": _w((lambda *s: torch.randn(*s, dtype=torch.bfloat16) * 0.05)(1024) * 16.0),
    }

def reference(A_u, A_log_A_real, A_A_imag, A_C_real, A_C_imag, A_log_dt, A_D_skip, B_q, B_k, B_v, B_shift_k, B_ssm_k, B_ssm_D, gate_w):
    def _A_ref(u, log_A_real, A_imag, C_real, C_imag, log_dt, D_skip):
        L = u.shape[1]
        dt = torch.exp(log_dt)
        A = -torch.exp(log_A_real) + 1j * A_imag
        C = (C_real + 1j * C_imag) * dt[:, None]
        pos = (lambda x, dt: x.to(dt))(torch.arange(L), log_dt.dtype)
        P = torch.exp((A * dt[:, None])[:, :, None] * pos[None, None, :])
        K = 2.0 * torch.einsum("dn,dnl->dl", C, P).real
        L2 = 2 * L
        u_t = (lambda x, *d: x.permute(*d))(u, 0, 2, 1)
        Kf = (lambda x, *a, **k: torch.fft.rfft(x.float(), *a, **k))(K, L2)
        Uf = (lambda x, *a, **k: torch.fft.rfft(x.float(), *a, **k))(u_t, L2)
        y = (lambda x, *a, **k: torch.fft.irfft(x, *a, **k).to(torch.bfloat16))(Uf * Kf[None, :, :], L2)[:, :, :L]
        y = (lambda x, *d: x.permute(*d))(y, 0, 2, 1)
        return y + u * D_skip[None, None, :]

    def _B_ref(q, k, v, shift_k, ssm_k, ssm_D):
        B, S, D = q.shape
        ks = shift_k.shape[-1]
        k_pad = _pad(k, ((0, 0), (ks - 1, 0), (0, 0)))
        k_shift = torch.zeros_like(k)
        for t in range(ks):
            k_shift = k_shift + k_pad[:, t:t + S, :] * shift_k[:, ks - 1 - t][None, None, :]
        kv = k_shift * v
        L = 2 * S
        kv_pad = _pad(kv, ((0, 0), (0, S), (0, 0)))
        kf_pad = _pad(ssm_k, ((0, 0), (0, S)))
        kv_f = (lambda x, axes=(-2,-1): torch.fft.rfft2(x.float(), dim=axes))(kv_pad[:, None, :, :], axes=(1, 2))
        kf_f = (lambda x, axes=(-2,-1): torch.fft.rfft2(x.float(), dim=axes))(kf_pad[:, None, :], axes=(1, 2))
        kf_f = (lambda x, *d: x.permute(*d))(kf_f, 1, 2, 0)
        y_f = kv_f * kf_f[None, :, :, :]
        y = (lambda x, s, axes=(-2,-1): torch.fft.irfft2(x, s=s, dim=axes).to(torch.bfloat16))(y_f, (1, L), axes=(1, 2))[:, 0, :S, :]
        y = y + kv * ssm_D[None, None, :]
        return q * y

    x = A_u
    g = _sigmoid((x * gate_w).sum(-1, keepdims=True))
    a = _A_ref(x, A_log_A_real, A_A_imag, A_C_real, A_C_imag, A_log_dt, A_D_skip)
    b = _B_ref(x, B_k, B_v, B_shift_k, B_ssm_k, B_ssm_D)
    return g * a + (1 - g) * b
```

```asm
; @launch grid=(256,1,1) block=(768,1,1) lds=163200
.amdgcn_target "amdgcn-amd-amdhsa--gfx950"
.text
.globl gated_mix__ssm_conv_s4d__ssm_conv_h3__prompt_kernel
.p2align 8
.type gated_mix__ssm_conv_s4d__ssm_conv_h3__prompt_kernel,@function
gated_mix__ssm_conv_s4d__ssm_conv_h3__prompt_kernel:
    s_cmp_ge_u32 s2, 256
    s_cbranch_scc1 KEND
    s_load_dwordx4 s[20:23], s[0:1], 64
    s_load_dwordx4 s[4:7], s[0:1], 0
    s_load_dwordx4 s[24:27], s[0:1], 80
    s_load_dwordx4 s[76:79], s[0:1], 112
    s_load_dwordx4 s[8:11], s[0:1], 16
    s_load_dwordx4 s[12:15], s[0:1], 32
    s_load_dwordx2 s[16:17], s[0:1], 48
    s_load_dwordx4 s[72:75], s[0:1], 96
    s_load_dwordx2 s[28:29], s[0:1], 128
    v_lshrrev_b32 v1, 6, v0
    v_and_b32 v2, 63, v0
    v_readfirstlane_b32 s48, v1
    v_and_b32 v4, 15, v2
    v_lshrrev_b32 v5, 4, v2
    s_and_b32 s49, s48, 3
    s_lshr_b32 s50, s48, 2
    s_cmp_eq_u32 s50, 2
    s_cbranch_scc1 HELP
    s_and_b32 s30, s2, 7
    s_lshl_b32 s30, s30, 5
    s_lshr_b32 s31, s2, 3
    s_add_u32 s30, s30, s31
    s_lshl_b32 s30, s30, 2
    s_add_u32 s31, s30, s49
    s_lshl_b32 s57, s31, 8
    s_lshl_b32 s58, s50, 7
    s_add_u32 s57, s57, s58
    v_lshl_add_u32 v26, v2, 1, s57
    s_lshl_b32 s57, s31, 1
    v_mov_b32 v7, s57
    s_waitcnt lgkmcnt(0)
    global_load_ushort v10, v26, s[6:7]
    global_load_ushort v11, v26, s[8:9]
    global_load_ushort v14, v7, s[14:15]
    global_load_ushort v12, v26, s[10:11]
    global_load_ushort v13, v26, s[12:13]
    global_load_ushort v15, v7, s[16:17]
    global_load_ushort v9, v7, s[72:73]
    s_branch CONVP
HELP:
    s_and_b32 s51, s2, 15
    s_lshr_b32 s56, s2, 4
    v_lshrrev_b32 v34, 3, v2
    v_and_b32 v35, 7, v2
    v_and_b32 v36, 1, v5
    v_lshlrev_b32 v36, 1, v36
    s_and_b32 s57, s49, 1
    s_lshl_b32 s57, s57, 2
    v_or_b32 v37, s57, v36
    v_xor_b32 v37, v37, v35
    v_lshlrev_b32 v37, 4, v37
    v_lshl_add_u32 v37, v34, 11, v37
    s_lshl_b32 s57, s56, 18
    s_lshl_b32 s58, s49, 16
    s_add_u32 s57, s57, s58
    s_lshl_b32 s58, s51, 7
    s_add_u32 s60, s57, s58
    s_lshl_b32 s61, s49, 12
    s_sub_u32 s62, s60, 8192
    s_add_u32 s57, s62, 0
    v_add_u32 v26, s57, v37
    s_add_u32 s57, s62, 16384
    v_add_u32 v27, s57, v37
    s_add_u32 s57, s62, 32768
    v_add_u32 v28, s57, v37
    s_add_u32 s57, s62, 49152
    v_add_u32 v29, s57, v37
    s_lshl_b32 s57, s51, 9
    s_lshl_b32 s58, s49, 7
    s_add_u32 s57, s57, s58
    v_lshl_add_u32 v43, v4, 3, s57
    s_waitcnt lgkmcnt(0)
    s_mov_b32 s36, s20
    s_and_b32 s37, s21, 0xffff
    s_mov_b32 s38, 4194304
    s_mov_b32 s39, 0x20000
    s_mov_b32 s40, s78
    s_and_b32 s41, s79, 0xffff
    s_mov_b32 s42, 256
    s_mov_b32 s43, 0x20000
    v_mov_b32 v46, 0
    s_or_b32 s57, s2, s49
    s_cmp_lg_u32 s57, 0
    s_cbranch_scc1 NONW
    s_memrealtime s[68:69]
    s_waitcnt lgkmcnt(0)
    s_or_b32 s68, s68, 1
    v_mov_b32 v54, s68
    v_mov_b32 v55, s69
    s_mov_b64 exec, 1
    buffer_store_dwordx2 v[54:55], v46, s[40:43], 0 offen sc1
    s_mov_b64 exec, -1
NONW:
    s_mov_b32 s32, s22
    s_and_b32 s33, s23, 0xffff
    s_mov_b32 s34, 4194304
    s_mov_b32 s35, 0x20000
    global_load_dwordx2 v[32:33], v43, s[24:25]
    s_add_u32 m0, s61, 102784
    s_nop 0
    buffer_load_dwordx4 v26, s[36:39], 0 offen lds
    s_add_u32 m0, s61, 103808
    s_nop 0
    buffer_load_dwordx4 v27, s[36:39], 0 offen lds
    s_add_u32 m0, s61, 104832
    s_nop 0
    buffer_load_dwordx4 v28, s[36:39], 0 offen lds
    s_add_u32 m0, s61, 105856
    s_nop 0
    buffer_load_dwordx4 v29, s[36:39], 0 offen lds
    s_cmp_lg_u32 s49, 3
    s_cbranch_scc1 NOX
    v_xor_b32 v44, v36, v35
    v_lshlrev_b32 v44, 4, v44
    v_lshl_add_u32 v44, v34, 11, v44
    s_lshl_b32 s57, s56, 18
    s_add_u32 s57, s57, 253952
    s_lshl_b32 s58, s51, 7
    s_add_u32 s57, s57, s58
    s_mov_b32 m0, 119168
    s_nop 0
    buffer_load_dwordx4 v44, s[36:39], s57 offen lds
NOX:
    s_add_u32 s57, s60, 0
    s_add_u32 m0, s61, 86400
    s_nop 0
    buffer_load_dwordx4 v37, s[32:35], s57 offen lds
    s_add_u32 s57, s60, 16384
    s_add_u32 m0, s61, 87424
    s_nop 0
    buffer_load_dwordx4 v37, s[32:35], s57 offen lds
    s_add_u32 s57, s60, 32768
    s_add_u32 m0, s61, 88448
    s_nop 0
    buffer_load_dwordx4 v37, s[32:35], s57 offen lds
    s_add_u32 s57, s60, 49152
    s_add_u32 m0, s61, 89472
    s_nop 0
    buffer_load_dwordx4 v37, s[32:35], s57 offen lds
    v_mov_b32 v25, 69888
    v_mov_b32 v21, 1
    v_mov_b32 v12, 0
    v_mov_b32 v13, 0
    v_mov_b32 v14, 0
    v_mov_b32 v15, 0
    v_and_b32 v10, 7, v2
    v_lshlrev_b32 v10, 4, v10
    v_add_u32 v10, 69888, v10
    ds_write_b128 v10, v[12:15]
    s_waitcnt lgkmcnt(0)
    s_barrier
    s_mov_b32 s44, s28
    s_and_b32 s45, s29, 0xffff
    s_mov_b32 s46, 12597248
    s_mov_b32 s47, 0x20000
    s_mov_b64 s[64:65], 1
    v_lshlrev_b32 v6, 4, v2
    s_and_b32 s30, s2, 7
    s_lshl_b32 s30, s30, 5
    s_lshr_b32 s31, s2, 3
    s_add_u32 s30, s30, s31
    s_lshl_b32 s30, s30, 2
    s_add_u32 s31, s30, s49
    v_lshrrev_b32 v46, 2, v4
    v_and_b32 v47, 3, v2
    v_lshrrev_b32 v48, 1, v47
    s_lshl_b32 s57, s49, 1
    v_add_u32 v48, s57, v48
    v_lshlrev_b32 v49, 1, v46
    v_xor_b32 v49, v48, v49
    v_lshlrev_b32 v49, 4, v49
    v_and_b32 v50, 1, v47
    v_lshlrev_b32 v50, 3, v50
    v_add_u32 v49, v49, v50
    v_lshl_add_u32 v49, v46, 9, v49
    v_lshl_add_u32 v49, v5, 12, v49
    v_add_u32 v49, 70016, v49
    v_lshrrev_b32 v51, 1, v46
    v_lshlrev_b32 v51, 1, v51
    v_and_b32 v52, 1, v5
    v_lshl_or_b32 v51, v52, 2, v51
    v_xor_b32 v52, v48, v51
    v_xor_b32 v53, 4, v52
    v_lshl_add_u32 v50, v46, 7, v50
    v_lshl_add_u32 v50, v5, 12, v50
    v_add_u32 v50, 86400, v50
    v_lshl_add_u32 v52, v52, 4, v50
    v_lshl_add_u32 v53, v53, 4, v50
    s_lshl_b32 s57, s51, 18
    s_lshl_b32 s58, s49, 16
    s_add_u32 s57, s57, s58
    s_lshl_b32 s58, s56, 6
    s_lshl_b32 s58, s56, 8
    s_add_u32 s57, s57, s58
    v_lshlrev_b32 v54, 12, v5
    v_lshl_add_u32 v54, v4, 4, v54
    v_add_u32 v54, s57, v54
    s_lshl_b32 s57, s49, 12
    s_add_u32 s57, s57, 146816
    v_or_b32 v60, 0, v5
    v_xor_b32 v60, v60, v4
    v_lshlrev_b32 v60, 4, v60
    v_lshl_add_u32 v60, v4, 8, v60
    v_add_u32 v16, s57, v60
    v_or_b32 v60, 4, v5
    v_xor_b32 v60, v60, v4
    v_lshlrev_b32 v60, 4, v60
    v_lshl_add_u32 v60, v4, 8, v60
    v_add_u32 v17, s57, v60
    v_or_b32 v60, 8, v5
    v_xor_b32 v60, v60, v4
    v_lshlrev_b32 v60, 4, v60
    v_lshl_add_u32 v60, v4, 8, v60
    v_add_u32 v18, s57, v60
    v_or_b32 v60, 12, v5
    v_xor_b32 v60, v60, v4
    v_lshlrev_b32 v60, 4, v60
    v_lshl_add_u32 v60, v4, 8, v60
    v_add_u32 v19, s57, v60
    v_add_u32 v60, 0, v5
    v_xor_b32 v61, v60, v4
    v_lshlrev_b32 v61, 4, v61
    v_lshl_add_u32 v61, v60, 8, v61
    v_add_u32 v7, s57, v61
    v_add_u32 v60, 4, v5
    v_xor_b32 v61, v60, v4
    v_lshlrev_b32 v61, 4, v61
    v_lshl_add_u32 v61, v60, 8, v61
    v_add_u32 v8, s57, v61
    v_add_u32 v60, 8, v5
    v_xor_b32 v61, v60, v4
    v_lshlrev_b32 v61, 4, v61
    v_lshl_add_u32 v61, v60, 8, v61
    v_add_u32 v9, s57, v61
    v_add_u32 v60, 12, v5
    v_xor_b32 v61, v60, v4
    v_lshlrev_b32 v61, 4, v61
    v_lshl_add_u32 v61, v60, 8, v61
    v_add_u32 v22, s57, v61
    v_mov_b32 v46, 0
    s_mov_b32 s32, s4
    s_and_b32 s33, s5, 0xffff
    s_mov_b32 s34, 4194304
    s_mov_b32 s35, 0x20000
    v_lshrrev_b32 v38, 5, v2
    v_lshlrev_b32 v38, 1, v38
    v_or_b32 v39, 0, v38
    v_xor_b32 v39, v39, v35
    v_lshlrev_b32 v39, 4, v39
    v_lshl_add_u32 v40, v34, 11, v39
    v_or_b32 v39, 4, v38
    v_xor_b32 v39, v39, v35
    v_lshlrev_b32 v39, 4, v39
    v_lshl_add_u32 v41, v34, 11, v39
    s_setprio 2
    s_waitcnt vmcnt(0)
    s_add_u32 s57, s60, 0
    s_add_u32 m0, s61, 70016
    s_nop 0
    buffer_load_dwordx4 v40, s[32:35], s57 offen lds
    s_add_u32 s57, s60, 16384
    s_add_u32 m0, s61, 71040
    s_nop 0
    buffer_load_dwordx4 v41, s[32:35], s57 offen lds
    s_add_u32 s57, s60, 32768
    s_add_u32 m0, s61, 72064
    s_nop 0
    buffer_load_dwordx4 v40, s[32:35], s57 offen lds
    s_add_u32 s57, s60, 49152
    s_add_u32 m0, s61, 73088
    s_nop 0
    buffer_load_dwordx4 v41, s[32:35], s57 offen lds
    s_waitcnt vmcnt(4)
    s_mov_b64 exec, 1
    ds_add_u32 v25, v21 offset:0
    s_mov_b64 exec, -1
    v_lshlrev_b32 v56, 16, v32
    v_and_b32 v57, 0xffff0000, v32
    v_lshlrev_b32 v58, 16, v33
    v_and_b32 v59, 0xffff0000, v33
    s_mov_b32 s71, 524288
SPL1:
    ds_read_b32 v23, v25 offset:0
    s_waitcnt lgkmcnt(0)
    v_readfirstlane_b32 s70, v23
    s_nop 1
    s_cmp_ge_u32 s70, 4
    s_cbranch_scc1 SPD1
    s_sub_u32 s71, s71, 1
    s_cmp_eq_u32 s71, 0
    s_cbranch_scc1 SPD1
    s_nop 7
    s_branch SPL1
SPD1:
    ds_read_b64_tr_b16 v[80:81], v52 offset:16384
    ds_read_b64_tr_b16 v[82:83], v52 offset:16896
    ds_read_b64_tr_b16 v[84:85], v52 offset:17408
    ds_read_b64_tr_b16 v[86:87], v52 offset:17920
    ds_read_b64_tr_b16 v[88:89], v52 offset:18432
    ds_read_b64_tr_b16 v[90:91], v52 offset:18944
    ds_read_b64_tr_b16 v[92:93], v52 offset:19456
    ds_read_b64_tr_b16 v[94:95], v52 offset:19968
    ds_read_b64_tr_b16 v[96:97], v53 offset:20480
    ds_read_b64_tr_b16 v[98:99], v52 offset:0
    ds_read_b64_tr_b16 v[100:101], v52 offset:512
    ds_read_b64_tr_b16 v[102:103], v52 offset:1024
    ds_read_b64_tr_b16 v[104:105], v52 offset:1536
    ds_read_b64_tr_b16 v[106:107], v52 offset:2048
    ds_read_b64_tr_b16 v[108:109], v52 offset:2560
    s_waitcnt lgkmcnt(6)
    ds_read_b64_tr_b16 v[110:111], v52 offset:3072
    ds_read_b64_tr_b16 v[112:113], v52 offset:3584
    v_lshlrev_b32 v114, 16, v80
    v_and_b32 v115, 0xffff0000, v80
    v_lshlrev_b32 v116, 16, v81
    v_and_b32 v117, 0xffff0000, v81
    v_lshlrev_b32 v118, 16, v82
    v_and_b32 v119, 0xffff0000, v82
    v_lshlrev_b32 v120, 16, v83
    v_and_b32 v121, 0xffff0000, v83
    v_lshlrev_b32 v122, 16, v84
    v_and_b32 v123, 0xffff0000, v84
    v_lshlrev_b32 v124, 16, v85
    v_and_b32 v125, 0xffff0000, v85
    v_lshlrev_b32 v126, 16, v86
    v_and_b32 v127, 0xffff0000, v86
    v_lshlrev_b32 v128, 16, v87
    v_and_b32 v129, 0xffff0000, v87
    v_lshlrev_b32 v130, 16, v88
    v_and_b32 v131, 0xffff0000, v88
    v_lshlrev_b32 v132, 16, v89
    v_and_b32 v133, 0xffff0000, v89
    v_lshlrev_b32 v134, 16, v90
    v_and_b32 v135, 0xffff0000, v90
    v_lshlrev_b32 v136, 16, v91
    v_and_b32 v137, 0xffff0000, v91
    v_lshlrev_b32 v138, 16, v92
    v_and_b32 v139, 0xffff0000, v92
    v_lshlrev_b32 v140, 16, v93
    v_and_b32 v141, 0xffff0000, v93
    v_lshlrev_b32 v142, 16, v94
    v_and_b32 v143, 0xffff0000, v94
    v_lshlrev_b32 v144, 16, v95
    v_and_b32 v145, 0xffff0000, v95
    v_lshlrev_b32 v146, 16, v96
    v_and_b32 v147, 0xffff0000, v96
    v_lshlrev_b32 v148, 16, v97
    v_and_b32 v149, 0xffff0000, v97
    v_mul_f32 v150, v56, v118
    v_mul_f32 v151, v56, v122
    v_mul_f32 v152, v56, v126
    v_mul_f32 v153, v56, v130
    v_mul_f32 v154, v56, v134
    v_mul_f32 v155, v56, v138
    v_mul_f32 v156, v56, v142
    v_mul_f32 v157, v56, v146
    v_mul_f32 v158, v56, v119
    v_mul_f32 v159, v56, v123
    v_mul_f32 v160, v56, v127
    v_mul_f32 v161, v56, v131
    v_mul_f32 v162, v56, v135
    v_mul_f32 v163, v56, v139
    v_mul_f32 v164, v56, v143
    v_mul_f32 v165, v56, v147
    v_fmac_f32 v150, v57, v117
    v_fmac_f32 v151, v57, v121
    v_fmac_f32 v152, v57, v125
    v_fmac_f32 v153, v57, v129
    v_fmac_f32 v154, v57, v133
    v_fmac_f32 v155, v57, v137
    v_fmac_f32 v156, v57, v141
    v_fmac_f32 v157, v57, v145
    v_fmac_f32 v158, v57, v118
    v_fmac_f32 v159, v57, v122
    v_fmac_f32 v160, v57, v126
    v_fmac_f32 v161, v57, v130
    v_fmac_f32 v162, v57, v134
    v_fmac_f32 v163, v57, v138
    v_fmac_f32 v164, v57, v142
    v_fmac_f32 v165, v57, v146
    v_fmac_f32 v150, v58, v116
    v_fmac_f32 v151, v58, v120
    v_fmac_f32 v152, v58, v124
    v_fmac_f32 v153, v58, v128
    v_fmac_f32 v154, v58, v132
    v_fmac_f32 v155, v58, v136
    v_fmac_f32 v156, v58, v140
    v_fmac_f32 v157, v58, v144
    v_fmac_f32 v158, v58, v117
    v_fmac_f32 v159, v58, v121
    v_fmac_f32 v160, v58, v125
    v_fmac_f32 v161, v58, v129
    v_fmac_f32 v162, v58, v133
    v_fmac_f32 v163, v58, v137
    v_fmac_f32 v164, v58, v141
    v_fmac_f32 v165, v58, v145
    v_fmac_f32 v150, v59, v115
    v_fmac_f32 v151, v59, v119
    v_fmac_f32 v152, v59, v123
    v_fmac_f32 v153, v59, v127
    v_fmac_f32 v154, v59, v131
    v_fmac_f32 v155, v59, v135
    v_fmac_f32 v156, v59, v139
    v_fmac_f32 v157, v59, v143
    v_fmac_f32 v158, v59, v116
    v_fmac_f32 v159, v59, v120
    v_fmac_f32 v160, v59, v124
    v_fmac_f32 v161, v59, v128
    v_fmac_f32 v162, v59, v132
    v_fmac_f32 v163, v59, v136
    v_fmac_f32 v164, v59, v140
    v_fmac_f32 v165, v59, v144
    s_waitcnt lgkmcnt(0)
    v_lshlrev_b32 v26, 16, v98
    v_mul_f32 v150, v150, v26
    v_lshlrev_b32 v27, 16, v100
    v_mul_f32 v151, v151, v27
    v_lshlrev_b32 v28, 16, v102
    v_mul_f32 v152, v152, v28
    v_lshlrev_b32 v29, 16, v104
    v_mul_f32 v153, v153, v29
    v_lshlrev_b32 v26, 16, v106
    v_mul_f32 v154, v154, v26
    v_lshlrev_b32 v27, 16, v108
    v_mul_f32 v155, v155, v27
    v_lshlrev_b32 v28, 16, v110
    v_mul_f32 v156, v156, v28
    v_lshlrev_b32 v29, 16, v112
    v_mul_f32 v157, v157, v29
    v_and_b32 v26, 0xffff0000, v98
    v_mul_f32 v158, v158, v26
    v_and_b32 v27, 0xffff0000, v100
    v_mul_f32 v159, v159, v27
    v_and_b32 v28, 0xffff0000, v102
    v_mul_f32 v160, v160, v28
    v_and_b32 v29, 0xffff0000, v104
    v_mul_f32 v161, v161, v29
    v_and_b32 v26, 0xffff0000, v106
    v_mul_f32 v162, v162, v26
    v_and_b32 v27, 0xffff0000, v108
    v_mul_f32 v163, v163, v27
    v_and_b32 v28, 0xffff0000, v110
    v_mul_f32 v164, v164, v28
    v_and_b32 v29, 0xffff0000, v112
    v_mul_f32 v165, v165, v29
    v_cvt_pk_bf16_f32 v80, v150, v151
    v_cvt_pk_bf16_f32 v81, v152, v153
    v_cvt_pk_bf16_f32 v82, v154, v155
    v_cvt_pk_bf16_f32 v83, v156, v157
    ds_write_b128 v16, v[80:83]
    v_cvt_pk_bf16_f32 v84, v158, v159
    v_cvt_pk_bf16_f32 v85, v160, v161
    v_cvt_pk_bf16_f32 v86, v162, v163
    v_cvt_pk_bf16_f32 v87, v164, v165
    ds_write_b128 v17, v[84:87]
    s_cmp_lg_u32 s49, 0
    s_cbranch_scc1 NNL
    buffer_load_dwordx2 v[62:63], v46, s[40:43], 0 offen sc1
NNL:
    v_mul_f32 v150, v56, v120
    v_mul_f32 v151, v56, v124
    v_mul_f32 v152, v56, v128
    v_mul_f32 v153, v56, v132
    v_mul_f32 v154, v56, v136
    v_mul_f32 v155, v56, v140
    v_mul_f32 v156, v56, v144
    v_mul_f32 v157, v56, v148
    v_mul_f32 v158, v56, v121
    v_mul_f32 v159, v56, v125
    v_mul_f32 v160, v56, v129
    v_mul_f32 v161, v56, v133
    v_mul_f32 v162, v56, v137
    v_mul_f32 v163, v56, v141
    v_mul_f32 v164, v56, v145
    v_mul_f32 v165, v56, v149
    v_fmac_f32 v150, v57, v119
    v_fmac_f32 v151, v57, v123
    v_fmac_f32 v152, v57, v127
    v_fmac_f32 v153, v57, v131
    v_fmac_f32 v154, v57, v135
    v_fmac_f32 v155, v57, v139
    v_fmac_f32 v156, v57, v143
    v_fmac_f32 v157, v57, v147
    v_fmac_f32 v158, v57, v120
    v_fmac_f32 v159, v57, v124
    v_fmac_f32 v160, v57, v128
    v_fmac_f32 v161, v57, v132
    v_fmac_f32 v162, v57, v136
    v_fmac_f32 v163, v57, v140
    v_fmac_f32 v164, v57, v144
    v_fmac_f32 v165, v57, v148
    v_fmac_f32 v150, v58, v118
    v_fmac_f32 v151, v58, v122
    v_fmac_f32 v152, v58, v126
    v_fmac_f32 v153, v58, v130
    v_fmac_f32 v154, v58, v134
    v_fmac_f32 v155, v58, v138
    v_fmac_f32 v156, v58, v142
    v_fmac_f32 v157, v58, v146
    v_fmac_f32 v158, v58, v119
    v_fmac_f32 v159, v58, v123
    v_fmac_f32 v160, v58, v127
    v_fmac_f32 v161, v58, v131
    v_fmac_f32 v162, v58, v135
    v_fmac_f32 v163, v58, v139
    v_fmac_f32 v164, v58, v143
    v_fmac_f32 v165, v58, v147
    v_fmac_f32 v150, v59, v117
    v_fmac_f32 v151, v59, v121
    v_fmac_f32 v152, v59, v125
    v_fmac_f32 v153, v59, v129
    v_fmac_f32 v154, v59, v133
    v_fmac_f32 v155, v59, v137
    v_fmac_f32 v156, v59, v141
    v_fmac_f32 v157, v59, v145
    v_fmac_f32 v158, v59, v118
    v_fmac_f32 v159, v59, v122
    v_fmac_f32 v160, v59, v126
    v_fmac_f32 v161, v59, v130
    v_fmac_f32 v162, v59, v134
    v_fmac_f32 v163, v59, v138
    v_fmac_f32 v164, v59, v142
    v_fmac_f32 v165, v59, v146
    v_lshlrev_b32 v26, 16, v99
    v_mul_f32 v150, v150, v26
    v_lshlrev_b32 v27, 16, v101
    v_mul_f32 v151, v151, v27
    v_lshlrev_b32 v28, 16, v103
    v_mul_f32 v152, v152, v28
    v_lshlrev_b32 v29, 16, v105
    v_mul_f32 v153, v153, v29
    v_lshlrev_b32 v26, 16, v107
    v_mul_f32 v154, v154, v26
    v_lshlrev_b32 v27, 16, v109
    v_mul_f32 v155, v155, v27
    v_lshlrev_b32 v28, 16, v111
    v_mul_f32 v156, v156, v28
    v_lshlrev_b32 v29, 16, v113
    v_mul_f32 v157, v157, v29
    v_and_b32 v26, 0xffff0000, v99
    v_mul_f32 v158, v158, v26
    v_and_b32 v27, 0xffff0000, v101
    v_mul_f32 v159, v159, v27
    v_and_b32 v28, 0xffff0000, v103
    v_mul_f32 v160, v160, v28
    v_and_b32 v29, 0xffff0000, v105
    v_mul_f32 v161, v161, v29
    v_and_b32 v26, 0xffff0000, v107
    v_mul_f32 v162, v162, v26
    v_and_b32 v27, 0xffff0000, v109
    v_mul_f32 v163, v163, v27
    v_and_b32 v28, 0xffff0000, v111
    v_mul_f32 v164, v164, v28
    v_and_b32 v29, 0xffff0000, v113
    v_mul_f32 v165, v165, v29
    v_cvt_pk_bf16_f32 v88, v150, v151
    v_cvt_pk_bf16_f32 v89, v152, v153
    v_cvt_pk_bf16_f32 v90, v154, v155
    v_cvt_pk_bf16_f32 v91, v156, v157
    ds_write_b128 v18, v[88:91]
    v_cvt_pk_bf16_f32 v92, v158, v159
    v_cvt_pk_bf16_f32 v93, v160, v161
    v_cvt_pk_bf16_f32 v94, v162, v163
    v_cvt_pk_bf16_f32 v95, v164, v165
    ds_write_b128 v19, v[92:95]
    s_waitcnt lgkmcnt(0)
    ds_read_b128 v[80:83], v7
    ds_read_b128 v[84:87], v8
    ds_read_b128 v[88:91], v9
    ds_read_b128 v[92:95], v22
    s_waitcnt lgkmcnt(3)
    s_mov_b32 s58, 4194304
    buffer_store_dwordx4 v[80:83], v54, s[44:47], s58 offen sc1
    s_waitcnt lgkmcnt(2)
    s_mov_b32 s58, 4210688
    buffer_store_dwordx4 v[84:87], v54, s[44:47], s58 offen sc1
    s_waitcnt lgkmcnt(1)
    s_mov_b32 s58, 4227072
    buffer_store_dwordx4 v[88:91], v54, s[44:47], s58 offen sc1
    s_waitcnt lgkmcnt(0)
    s_mov_b32 s58, 4243456
    buffer_store_dwordx4 v[92:95], v54, s[44:47], s58 offen sc1
    s_waitcnt vmcnt(5)
    s_cmp_eq_u32 s49, 0
    s_cbranch_scc1 XL0
    s_waitcnt vmcnt(4)
XL0:
    s_mov_b64 exec, 1
    ds_add_u32 v25, v21 offset:4
    s_mov_b64 exec, -1
    v_lshlrev_b32 v26, 5, v2
    s_lshl_b32 s57, s2, 3
    s_lshl_b32 s58, s49, 1
    s_add_u32 s59, s57, s58
    s_lshl_b32 s57, s59, 11
    v_add_u32 v27, s57, v26
    s_mov_b32 s71, 524288
SPL2:
    ds_read_b32 v23, v25 offset:4
    s_waitcnt lgkmcnt(0)
    v_readfirstlane_b32 s70, v23
    s_nop 1
    s_cmp_ge_u32 s70, 4
    s_cbranch_scc1 SPD2
    s_sub_u32 s71, s71, 1
    s_cmp_eq_u32 s71, 0
    s_cbranch_scc1 SPD2
    s_nop 7
    s_branch SPL2
SPD2:
    ds_read_b64_tr_b16 v[64:65], v49 offset:0
    ds_read_b64_tr_b16 v[66:67], v49 offset:2048
    ds_read_b64_tr_b16 v[68:69], v49 offset:128
    ds_read_b64_tr_b16 v[70:71], v49 offset:2176
    ds_read_b64_tr_b16 v[72:73], v49 offset:256
    ds_read_b64_tr_b16 v[74:75], v49 offset:2304
    ds_read_b64_tr_b16 v[76:77], v49 offset:384
    ds_read_b64_tr_b16 v[78:79], v49 offset:2432
    s_waitcnt lgkmcnt(6)
    ds_write_b128 v16, v[64:67]
    s_waitcnt lgkmcnt(5)
    ds_write_b128 v17, v[68:71]
    s_waitcnt lgkmcnt(4)
    ds_write_b128 v18, v[72:75]
    s_waitcnt lgkmcnt(3)
    ds_write_b128 v19, v[76:79]
    s_waitcnt lgkmcnt(0)
    ds_read_b128 v[64:67], v7
    ds_read_b128 v[68:71], v8
    ds_read_b128 v[72:75], v9
    ds_read_b128 v[76:79], v22
    s_waitcnt lgkmcnt(3)
    s_mov_b32 s58, 0
    buffer_store_dwordx4 v[64:67], v54, s[44:47], s58 offen sc1
    s_waitcnt lgkmcnt(2)
    s_mov_b32 s58, 16384
    buffer_store_dwordx4 v[68:71], v54, s[44:47], s58 offen sc1
    s_waitcnt lgkmcnt(1)
    s_mov_b32 s58, 32768
    buffer_store_dwordx4 v[72:75], v54, s[44:47], s58 offen sc1
    s_waitcnt lgkmcnt(0)
    s_mov_b32 s58, 49152
    buffer_store_dwordx4 v[76:79], v54, s[44:47], s58 offen sc1
    global_load_dwordx4 v[96:99], v27, s[4:5]
    global_load_dwordx4 v[100:103], v27, s[4:5] offset:16
    global_load_dwordx4 v[104:107], v27, s[4:5] offset:2048
    global_load_dwordx4 v[108:111], v27, s[4:5] offset:2064
    global_load_dwordx4 v[112:115], v26, s[74:75]
    global_load_dwordx4 v[116:119], v26, s[74:75] offset:16
    s_lshl_b32 s66, s51, 8
    s_lshl_b32 s58, s56, 3
    s_add_u32 s66, s66, s58
    s_add_u32 s66, s66, 12591104
    s_waitcnt vmcnt(10)
    s_mov_b64 exec, 1
    ds_add_u32 v25, v21 offset:8
    s_mov_b64 exec, -1
    s_cmp_lg_u32 s49, 0
    s_cbranch_scc1 NPKV
    s_mov_b32 s71, 131072
NONL:
    v_readfirstlane_b32 s68, v62
    s_memrealtime s[34:35]
    s_waitcnt lgkmcnt(0)
    s_sub_u32 s34, s34, s68
    s_add_u32 s34, s34, 400
    s_cmp_lt_u32 s34, 2400
    s_cselect_b32 s34, s68, 0
    s_cmp_lg_u32 s34, 0
    s_cbranch_scc1 NONOK
    s_sub_u32 s71, s71, 1
    s_cmp_eq_u32 s71, 0
    s_cbranch_scc1 NONOK
    s_cmp_lt_u32 s71, 131040
    s_cselect_b32 s34, s68, 0
    s_cmp_lg_u32 s34, 0
    s_cbranch_scc1 NONOK
    s_sleep 2
    buffer_load_dwordx2 v[62:63], v46, s[40:43], 0 offen sc1
    s_waitcnt vmcnt(0)
    s_branch NONL
NONOK:
    s_mov_b32 s71, 524288
SPL3:
    ds_read_b32 v23, v25 offset:8
    s_waitcnt lgkmcnt(0)
    v_readfirstlane_b32 s70, v23
    s_nop 1
    s_cmp_ge_u32 s70, 4
    s_cbranch_scc1 SPD3
    s_sub_u32 s71, s71, 1
    s_cmp_eq_u32 s71, 0
    s_cbranch_scc1 SPD3
    s_nop 7
    s_branch SPL3
SPD3:
    s_mov_b64 exec, 1
    buffer_store_dwordx2 v[62:63], v46, s[44:47], s66 offen sc1
    s_mov_b64 exec, -1
    s_waitcnt vmcnt(7)
    s_branch NPKV2
NPKV:
    s_waitcnt vmcnt(6)
NPKV2:
    s_mov_b64 exec, 1
    ds_add_u32 v25, v21 offset:12
    s_mov_b64 exec, -1
    s_cmp_lg_u32 s49, 0
    s_cbranch_scc1 NPU
    s_mov_b32 s71, 524288
SPL4:
    ds_read_b32 v23, v25 offset:12
    s_waitcnt lgkmcnt(0)
    v_readfirstlane_b32 s70, v23
    s_nop 1
    s_cmp_ge_u32 s70, 4
    s_cbranch_scc1 SPD4
    s_sub_u32 s71, s71, 1
    s_cmp_eq_u32 s71, 0
    s_cbranch_scc1 SPD4
    s_nop 7
    s_branch SPL4
SPD4:
    s_mov_b64 exec, 1
    buffer_store_dwordx2 v[62:63], v46, s[44:47], s66 offen offset:128 sc1
    s_mov_b64 exec, -1
NPU:
    s_waitcnt vmcnt(2)
    s_cmp_eq_u32 s49, 0
    s_cbranch_scc1 GOK
    s_waitcnt vmcnt(0)
GOK:
    v_mov_b32 v120, 0
    v_mov_b32 v122, 0
    v_mov_b32 v121, 0
    v_mov_b32 v123, 0
    v_dot2c_f32_bf16 v120, v96, v112
    v_dot2c_f32_bf16 v122, v100, v116
    v_dot2c_f32_bf16 v121, v104, v112
    v_dot2c_f32_bf16 v123, v108, v116
    v_dot2c_f32_bf16 v120, v97, v113
    v_dot2c_f32_bf16 v122, v101, v117
    v_dot2c_f32_bf16 v121, v105, v113
    v_dot2c_f32_bf16 v123, v109, v117
    v_dot2c_f32_bf16 v120, v98, v114
    v_dot2c_f32_bf16 v122, v102, v118
    v_dot2c_f32_bf16 v121, v106, v114
    v_dot2c_f32_bf16 v123, v110, v118
    v_dot2c_f32_bf16 v120, v99, v115
    v_dot2c_f32_bf16 v122, v103, v119
    v_dot2c_f32_bf16 v121, v107, v115
    v_dot2c_f32_bf16 v123, v111, v119
    s_nop 3
    v_add_f32 v120, v120, v122
    v_add_f32 v121, v121, v123
    s_nop 0
    v_add_f32_dpp v120, v120, v120 row_shr:1 row_mask:0xf bank_mask:0xf bound_ctrl:0
    v_add_f32_dpp v121, v121, v121 row_shr:1 row_mask:0xf bank_mask:0xf bound_ctrl:0
    s_nop 0
    v_add_f32_dpp v120, v120, v120 row_shr:2 row_mask:0xf bank_mask:0xf bound_ctrl:0
    v_add_f32_dpp v121, v121, v121 row_shr:2 row_mask:0xf bank_mask:0xf bound_ctrl:0
    s_nop 0
    v_add_f32_dpp v120, v120, v120 row_shr:4 row_mask:0xf bank_mask:0xf bound_ctrl:0
    v_add_f32_dpp v121, v121, v121 row_shr:4 row_mask:0xf bank_mask:0xf bound_ctrl:0
    s_nop 0
    v_add_f32_dpp v120, v120, v120 row_shr:8 row_mask:0xf bank_mask:0xf bound_ctrl:0
    v_add_f32_dpp v121, v121, v121 row_shr:8 row_mask:0xf bank_mask:0xf bound_ctrl:0
    s_nop 0
    v_add_f32_dpp v120, v120, v120 row_bcast:15 row_mask:0xa bank_mask:0xf
    v_add_f32_dpp v121, v121, v121 row_bcast:15 row_mask:0xa bank_mask:0xf
    s_nop 0
    v_add_f32_dpp v120, v120, v120 row_bcast:31 row_mask:0xc bank_mask:0xf
    v_add_f32_dpp v121, v121, v121 row_bcast:31 row_mask:0xc bank_mask:0xf
    v_readlane_b32 s57, v120, 63
    v_readlane_b32 s58, v121, 63
    s_nop 0
    v_mov_b32 v120, s57
    v_mov_b32 v121, s58
    v_cndmask_b32 v120, v121, v120, s[64:65]
    v_cvt_pk_bf16_f32 v120, v120, v120
    v_lshlrev_b32 v120, 16, v120
    s_mov_b32 s62, 1069066811
    v_mul_f32 v120, s62, v120
    v_sub_f32 v120, 0, v120
    v_exp_f32 v120, v120
    s_nop 0
    v_add_f32 v120, 1.0, v120
    v_rcp_f32 v120, v120
    s_nop 0
    v_cvt_pk_bf16_f32 v120, v120, v120
    v_lshlrev_b32 v120, 16, v120
    v_sub_f32 v121, 1.0, v120
    v_cvt_pk_bf16_f32 v120, v120, v121
    s_lshl_b32 s57, s59, 2
    s_add_u32 s57, s57, 12582912
    v_lshlrev_b32 v121, 2, v2
    s_mov_b64 exec, 3
    buffer_store_dword v120, v121, s[44:47], s57 offen sc1
    s_mov_b64 exec, -1
    s_lshl_b32 s58, s31, 12
    s_mul_i32 s59, s49, 8736
    s_add_u32 s59, s59, 4256
    v_bfe_u32 v11, v2, 2, 2
    v_mul_u32_u24 v11, 1152, v11
    v_lshl_add_u32 v11, v5, 6, v11
    v_and_b32 v12, 3, v2
    v_lshl_add_u32 v11, v12, 4, v11
    v_add_u32 v11, s59, v11
    v_add_u32 v10, 34944, v11
    s_cmp_lg_u32 s49, 0
    s_cbranch_scc1 POLLO
    s_lshr_b32 s57, s30, 6
    s_lshl_b32 s57, s57, 8
    s_add_u32 s57, s57, 12591104
    v_lshlrev_b32 v14, 3, v2
    s_mov_b32 s71, 131072
    s_mov_b32 s70, 0
    s_mov_b32 s33, 0
POLL:
    s_mov_b64 exec, 0xffffffff
    buffer_load_dwordx2 v[12:13], v14, s[44:47], s57 offen sc1
    s_waitcnt vmcnt(0)
    v_xor_b32 v12, v12, v62
    v_xor_b32 v13, v13, v63
    v_or_b32 v12, v12, v13
    v_cmp_ne_u32 vcc, 0, v12
    s_mov_b64 exec, -1
    s_mov_b32 s67, vcc_lo
    s_cmp_lg_u32 s33, 0
    s_cbranch_scc1 G2D
    ds_read_b32 v23, v25 offset:32
    s_waitcnt lgkmcnt(0)
    v_readfirstlane_b32 s63, v23
    s_nop 1
    s_cmp_lt_u32 s63, 3
    s_cbranch_scc1 G2D
    s_lshl_b32 s63, s2, 3
    s_add_u32 s63, s63, 12595200
    s_mov_b64 exec, 1
    buffer_store_dwordx2 v[62:63], v46, s[44:47], s63 offen sc1
    s_mov_b64 exec, -1
    s_mov_b32 s33, 1
G2D:
    s_sub_u32 s71, s71, 1
    s_cmp_eq_u32 s71, 0
    s_cselect_b32 s67, 0, s67
    s_cmp_lg_u32 s70, 0
    s_cbranch_scc1 POLL2
    s_and_b32 s63, s67, 0xffff
    s_cmp_lg_u32 s63, 0
    s_cbranch_scc1 POLLS
    s_mov_b64 exec, 1
    ds_add_u32 v25, v21 offset:16
    s_mov_b64 exec, -1
    s_add_u32 s59, s58, 4194304
    buffer_load_dwordx4 v[80:83], v6, s[44:47], s59 offen sc1
    s_add_u32 s59, s58, 4195328
    buffer_load_dwordx4 v[84:87], v6, s[44:47], s59 offen sc1
    s_add_u32 s59, s58, 4196352
    buffer_load_dwordx4 v[88:91], v6, s[44:47], s59 offen sc1
    s_add_u32 s59, s58, 4197376
    buffer_load_dwordx4 v[92:95], v6, s[44:47], s59 offen sc1
    s_mov_b32 s70, 1
POLL2:
    s_lshr_b32 s63, s67, 16
    s_cmp_eq_u32 s63, 0
    s_cbranch_scc1 POLLD
    s_cmp_eq_u32 s70, 2
    s_cbranch_scc1 POLLS
    s_waitcnt vmcnt(0)
    ds_write_b128 v10, v[80:83] offset:0
    ds_write_b128 v10, v[84:87] offset:256
    ds_write_b128 v10, v[88:91] offset:512
    ds_write_b128 v10, v[92:95] offset:768
    s_waitcnt lgkmcnt(0)
    s_mov_b64 exec, 1
    ds_add_u32 v25, v21 offset:24
    s_mov_b64 exec, -1
    s_mov_b32 s70, 2
POLLS:
    s_sleep 1
    s_branch POLL
POLLD:
    s_mov_b64 exec, 1
    ds_add_u32 v25, v21 offset:20
    s_mov_b64 exec, -1
    s_add_u32 s59, s58, 0
    buffer_load_dwordx4 v[64:67], v6, s[44:47], s59 offen sc1
    s_add_u32 s59, s58, 1024
    buffer_load_dwordx4 v[68:71], v6, s[44:47], s59 offen sc1
    s_add_u32 s59, s58, 2048
    buffer_load_dwordx4 v[72:75], v6, s[44:47], s59 offen sc1
    s_add_u32 s59, s58, 3072
    buffer_load_dwordx4 v[76:79], v6, s[44:47], s59 offen sc1
    s_cmp_eq_u32 s70, 2
    s_cbranch_scc1 QB_DONE
    s_branch QB_W
POLLO:
    s_waitcnt vmcnt(0)
    s_mov_b64 exec, 1
    ds_add_u32 v25, v21 offset:32
    s_mov_b64 exec, -1
    s_mov_b32 s71, 524288
SPL5:
    ds_read_b32 v23, v25 offset:16
    s_waitcnt lgkmcnt(0)
    v_readfirstlane_b32 s70, v23
    s_nop 1
    s_cmp_ge_u32 s70, 1
    s_cbranch_scc1 SPD5
    s_sub_u32 s71, s71, 1
    s_cmp_eq_u32 s71, 0
    s_cbranch_scc1 SPD5
    s_sleep 1
    s_branch SPL5
SPD5:
    s_add_u32 s59, s58, 4194304
    buffer_load_dwordx4 v[80:83], v6, s[44:47], s59 offen sc1
    s_add_u32 s59, s58, 4195328
    buffer_load_dwordx4 v[84:87], v6, s[44:47], s59 offen sc1
    s_add_u32 s59, s58, 4196352
    buffer_load_dwordx4 v[88:91], v6, s[44:47], s59 offen sc1
    s_add_u32 s59, s58, 4197376
    buffer_load_dwordx4 v[92:95], v6, s[44:47], s59 offen sc1
    ds_read_b32 v23, v25 offset:20
    s_waitcnt lgkmcnt(0)
    v_readfirstlane_b32 s70, v23
    s_nop 1
    s_cmp_ge_u32 s70, 1
    s_cbranch_scc1 POLLO2
    s_waitcnt vmcnt(0)
    ds_write_b128 v10, v[80:83] offset:0
    ds_write_b128 v10, v[84:87] offset:256
    ds_write_b128 v10, v[88:91] offset:512
    ds_write_b128 v10, v[92:95] offset:768
    s_waitcnt lgkmcnt(0)
    s_mov_b64 exec, 1
    ds_add_u32 v25, v21 offset:24
    s_mov_b64 exec, -1
    s_mov_b32 s71, 524288
SPL6:
    ds_read_b32 v23, v25 offset:20
    s_waitcnt lgkmcnt(0)
    v_readfirstlane_b32 s70, v23
    s_nop 1
    s_cmp_ge_u32 s70, 1
    s_cbranch_scc1 SPD6
    s_sub_u32 s71, s71, 1
    s_cmp_eq_u32 s71, 0
    s_cbranch_scc1 SPD6
    s_nop 7
    s_branch SPL6
SPD6:
    s_add_u32 s59, s58, 0
    buffer_load_dwordx4 v[64:67], v6, s[44:47], s59 offen sc1
    s_add_u32 s59, s58, 1024
    buffer_load_dwordx4 v[68:71], v6, s[44:47], s59 offen sc1
    s_add_u32 s59, s58, 2048
    buffer_load_dwordx4 v[72:75], v6, s[44:47], s59 offen sc1
    s_add_u32 s59, s58, 3072
    buffer_load_dwordx4 v[76:79], v6, s[44:47], s59 offen sc1
    s_branch QB_DONE
POLLO2:
    s_add_u32 s59, s58, 0
    buffer_load_dwordx4 v[64:67], v6, s[44:47], s59 offen sc1
    s_add_u32 s59, s58, 1024
    buffer_load_dwordx4 v[68:71], v6, s[44:47], s59 offen sc1
    s_add_u32 s59, s58, 2048
    buffer_load_dwordx4 v[72:75], v6, s[44:47], s59 offen sc1
    s_add_u32 s59, s58, 3072
    buffer_load_dwordx4 v[76:79], v6, s[44:47], s59 offen sc1
QB_W:
    s_waitcnt vmcnt(4)
    ds_write_b128 v10, v[80:83] offset:0
    ds_write_b128 v10, v[84:87] offset:256
    ds_write_b128 v10, v[88:91] offset:512
    ds_write_b128 v10, v[92:95] offset:768
    s_waitcnt lgkmcnt(0)
    s_mov_b64 exec, 1
    ds_add_u32 v25, v21 offset:24
    s_mov_b64 exec, -1
QB_DONE:
    s_waitcnt vmcnt(0)
    ds_write_b128 v11, v[64:67] offset:0
    ds_write_b128 v11, v[68:71] offset:256
    ds_write_b128 v11, v[72:75] offset:512
    ds_write_b128 v11, v[76:79] offset:768
    s_waitcnt lgkmcnt(0)
    s_mov_b64 exec, 1
    ds_add_u32 v25, v21 offset:28
    s_mov_b64 exec, -1
    s_cmp_lg_u32 s49, 0
    s_cbranch_scc1 PAO
    s_cmp_lg_u32 s33, 0
    s_cbranch_scc1 G2E
    s_mov_b32 s71, 524288
SPL7:
    ds_read_b32 v23, v25 offset:32
    s_waitcnt lgkmcnt(0)
    v_readfirstlane_b32 s70, v23
    s_nop 1
    s_cmp_ge_u32 s70, 3
    s_cbranch_scc1 SPD7
    s_sub_u32 s71, s71, 1
    s_cmp_eq_u32 s71, 0
    s_cbranch_scc1 SPD7
    s_nop 7
    s_branch SPL7
SPD7:
    s_lshl_b32 s57, s2, 3
    s_add_u32 s57, s57, 12595200
    s_mov_b64 exec, 1
    buffer_store_dwordx2 v[62:63], v46, s[44:47], s57 offen sc1
    s_mov_b64 exec, -1
G2E:
    s_mov_b32 s71, 131072
PA:
    s_mov_b32 s57, 12595200
    buffer_load_dwordx4 v[64:67], v6, s[44:47], s57 offen sc1
    buffer_load_dwordx4 v[68:71], v6, s[44:47], s57 offen offset:1024 sc1
    s_waitcnt vmcnt(0)
    v_xor_b32 v64, v64, v62
    v_xor_b32 v65, v65, v63
    v_xor_b32 v66, v66, v62
    v_xor_b32 v67, v67, v63
    v_xor_b32 v68, v68, v62
    v_xor_b32 v69, v69, v63
    v_xor_b32 v70, v70, v62
    v_xor_b32 v71, v71, v63
    v_or_b32 v64, v64, v65
    v_or_b32 v64, v64, v66
    v_or_b32 v64, v64, v67
    v_or_b32 v64, v64, v68
    v_or_b32 v64, v64, v69
    v_or_b32 v64, v64, v70
    v_or_b32 v64, v64, v71
    v_cmp_ne_u32 vcc, 0, v64
    s_nop 1
    s_cmp_eq_u64 vcc, 0
    s_cbranch_scc1 PAD
    s_sub_u32 s71, s71, 1
    s_cmp_eq_u32 s71, 0
    s_cbranch_scc1 PAD
    s_sleep 8
    s_branch PA
PAD:
    s_mov_b64 exec, 1
    ds_add_u32 v25, v21 offset:36
    s_mov_b64 exec, -1
    s_branch PAE
PAO:
    s_mov_b32 s71, 524288
SPL8:
    ds_read_b32 v23, v25 offset:36
    s_waitcnt lgkmcnt(0)
    v_readfirstlane_b32 s70, v23
    s_nop 1
    s_cmp_ge_u32 s70, 1
    s_cbranch_scc1 SPD8
    s_sub_u32 s71, s71, 1
    s_cmp_eq_u32 s71, 0
    s_cbranch_scc1 SPD8
    s_sleep 4
    s_branch SPL8
SPD8:
PAE:
    s_mov_b32 s36, s76
    s_and_b32 s37, s77, 0xffff
    s_mov_b32 s38, 4194304
    s_mov_b32 s39, 0x20000
    s_lshl_b32 s57, s49, 8
    v_lshl_add_u32 v49, v2, 2, s57
    s_mov_b32 s59, 12582912
    buffer_load_dword v96, v49, s[44:47], s59 offen sc1
    s_mov_b32 s59, 12583936
    buffer_load_dword v97, v49, s[44:47], s59 offen sc1
    s_mov_b32 s59, 12584960
    buffer_load_dword v98, v49, s[44:47], s59 offen sc1
    s_mov_b32 s59, 12585984
    buffer_load_dword v99, v49, s[44:47], s59 offen sc1
    s_mov_b32 s59, 12587008
    buffer_load_dword v100, v49, s[44:47], s59 offen sc1
    s_mov_b32 s59, 12588032
    buffer_load_dword v101, v49, s[44:47], s59 offen sc1
    s_mov_b32 s59, 12589056
    buffer_load_dword v102, v49, s[44:47], s59 offen sc1
    s_mov_b32 s59, 12590080
    buffer_load_dword v103, v49, s[44:47], s59 offen sc1
    v_lshrrev_b32 v10, 2, v4
    v_mul_u32_u24 v10, 5184, v10
    v_and_b32 v11, 3, v2
    v_lshl_add_u32 v10, v11, 3, v10
    v_mul_u32_u24 v11, 40, v5
    v_add_u32 v10, v10, v11
    s_mul_i32 s59, s49, 160
    s_add_u32 s59, s59, 70016
    v_add_u32 v50, s59, v10
    s_lshl_b32 s59, s49, 17
    s_lshl_b32 s60, s30, 1
    s_add_u32 s59, s59, s60
    v_lshlrev_b32 v10, 11, v2
    v_add_u32 v51, s59, v10
    s_waitcnt vmcnt(0)
    s_mov_b32 s71, 524288
SPL9:
    ds_read_b32 v23, v25 offset:40
    s_waitcnt lgkmcnt(0)
    v_readfirstlane_b32 s70, v23
    s_nop 1
    s_cmp_ge_u32 s70, 4
    s_cbranch_scc1 SPD9
    s_sub_u32 s71, s71, 1
    s_cmp_eq_u32 s71, 0
    s_cbranch_scc1 SPD9
    s_sleep 4
    s_branch SPL9
SPD9:
    s_mov_b32 s71, 524288
SPL10:
    ds_read_b32 v23, v25 offset:56
    s_waitcnt lgkmcnt(0)
    v_readfirstlane_b32 s70, v23
    s_nop 1
    s_cmp_ge_u32 s70, 4
    s_cbranch_scc1 SPD10
    s_sub_u32 s71, s71, 1
    s_cmp_eq_u32 s71, 0
    s_cbranch_scc1 SPD10
    s_sleep 4
    s_branch SPL10
SPD10:
    ds_read_b64_tr_b16 v[64:65], v50 offset:0
    ds_read_b64_tr_b16 v[66:67], v50 offset:20736
    ds_read_b64_tr_b16 v[68:69], v50 offset:640
    ds_read_b64_tr_b16 v[70:71], v50 offset:21376
    ds_read_b64_tr_b16 v[72:73], v50 offset:1280
    ds_read_b64_tr_b16 v[74:75], v50 offset:22016
    ds_read_b64_tr_b16 v[76:77], v50 offset:1920
    ds_read_b64_tr_b16 v[78:79], v50 offset:22656
    ds_read_b64_tr_b16 v[80:81], v50 offset:2560
    ds_read_b64_tr_b16 v[82:83], v50 offset:23296
    s_waitcnt lgkmcnt(8)
    v_lshlrev_b32 v34, 16, v96
    v_and_b32 v35, 0xffff0000, v96
    v_lshlrev_b32 v26, 16, v64
    v_and_b32 v27, 0xffff0000, v64
    v_lshlrev_b32 v28, 16, v65
    v_and_b32 v29, 0xffff0000, v65
    v_lshlrev_b32 v30, 16, v66
    v_and_b32 v31, 0xffff0000, v66
    v_lshlrev_b32 v32, 16, v67
    v_and_b32 v33, 0xffff0000, v67
    v_mul_f32 v26, v26, v34
    v_mul_f32 v27, v27, v34
    v_mul_f32 v28, v28, v34
    v_mul_f32 v29, v29, v34
    v_fmac_f32 v26, v30, v35
    v_fmac_f32 v27, v31, v35
    v_fmac_f32 v28, v32, v35
    v_fmac_f32 v29, v33, v35
    v_cvt_pk_bf16_f32 v64, v26, v27
    v_cvt_pk_bf16_f32 v65, v28, v29
    s_mov_b32 s59, 0
    buffer_store_dwordx2 v[64:65], v51, s[36:39], s59 offen
    s_waitcnt lgkmcnt(6)
    v_lshlrev_b32 v34, 16, v97
    v_and_b32 v35, 0xffff0000, v97
    v_lshlrev_b32 v26, 16, v68
    v_and_b32 v27, 0xffff0000, v68
    v_lshlrev_b32 v28, 16, v69
    v_and_b32 v29, 0xffff0000, v69
    v_lshlrev_b32 v30, 16, v70
    v_and_b32 v31, 0xffff0000, v70
    v_lshlrev_b32 v32, 16, v71
    v_and_b32 v33, 0xffff0000, v71
    v_mul_f32 v26, v26, v34
    v_mul_f32 v27, v27, v34
    v_mul_f32 v28, v28, v34
    v_mul_f32 v29, v29, v34
    v_fmac_f32 v26, v30, v35
    v_fmac_f32 v27, v31, v35
    v_fmac_f32 v28, v32, v35
    v_fmac_f32 v29, v33, v35
    v_cvt_pk_bf16_f32 v68, v26, v27
    v_cvt_pk_bf16_f32 v69, v28, v29
    s_mov_b32 s59, 524288
    buffer_store_dwordx2 v[68:69], v51, s[36:39], s59 offen
    s_waitcnt lgkmcnt(4)
    v_lshlrev_b32 v34, 16, v98
    v_and_b32 v35, 0xffff0000, v98
    v_lshlrev_b32 v26, 16, v72
    v_and_b32 v27, 0xffff0000, v72
    v_lshlrev_b32 v28, 16, v73
    v_and_b32 v29, 0xffff0000, v73
    v_lshlrev_b32 v30, 16, v74
    v_and_b32 v31, 0xffff0000, v74
    v_lshlrev_b32 v32, 16, v75
    v_and_b32 v33, 0xffff0000, v75
    v_mul_f32 v26, v26, v34
    v_mul_f32 v27, v27, v34
    v_mul_f32 v28, v28, v34
    v_mul_f32 v29, v29, v34
    v_fmac_f32 v26, v30, v35
    v_fmac_f32 v27, v31, v35
    v_fmac_f32 v28, v32, v35
    v_fmac_f32 v29, v33, v35
    v_cvt_pk_bf16_f32 v72, v26, v27
    v_cvt_pk_bf16_f32 v73, v28, v29
    s_mov_b32 s59, 1048576
    buffer_store_dwordx2 v[72:73], v51, s[36:39], s59 offen
    s_waitcnt lgkmcnt(2)
    v_lshlrev_b32 v34, 16, v99
    v_and_b32 v35, 0xffff0000, v99
    v_lshlrev_b32 v26, 16, v76
    v_and_b32 v27, 0xffff0000, v76
    v_lshlrev_b32 v28, 16, v77
    v_and_b32 v29, 0xffff0000, v77
    v_lshlrev_b32 v30, 16, v78
    v_and_b32 v31, 0xffff0000, v78
    v_lshlrev_b32 v32, 16, v79
    v_and_b32 v33, 0xffff0000, v79
    v_mul_f32 v26, v26, v34
    v_mul_f32 v27, v27, v34
    v_mul_f32 v28, v28, v34
    v_mul_f32 v29, v29, v34
    v_fmac_f32 v26, v30, v35
    v_fmac_f32 v27, v31, v35
    v_fmac_f32 v28, v32, v35
    v_fmac_f32 v29, v33, v35
    v_cvt_pk_bf16_f32 v76, v26, v27
    v_cvt_pk_bf16_f32 v77, v28, v29
    s_mov_b32 s59, 1572864
    buffer_store_dwordx2 v[76:77], v51, s[36:39], s59 offen
    s_waitcnt lgkmcnt(0)
    v_lshlrev_b32 v34, 16, v100
    v_and_b32 v35, 0xffff0000, v100
    v_lshlrev_b32 v26, 16, v80
    v_and_b32 v27, 0xffff0000, v80
    v_lshlrev_b32 v28, 16, v81
    v_and_b32 v29, 0xffff0000, v81
    v_lshlrev_b32 v30, 16, v82
    v_and_b32 v31, 0xffff0000, v82
    v_lshlrev_b32 v32, 16, v83
    v_and_b32 v33, 0xffff0000, v83
    v_mul_f32 v26, v26, v34
    v_mul_f32 v27, v27, v34
    v_mul_f32 v28, v28, v34
    v_mul_f32 v29, v29, v34
    v_fmac_f32 v26, v30, v35
    v_fmac_f32 v27, v31, v35
    v_fmac_f32 v28, v32, v35
    v_fmac_f32 v29, v33, v35
    v_cvt_pk_bf16_f32 v80, v26, v27
    v_cvt_pk_bf16_f32 v81, v28, v29
    s_mov_b32 s59, 2097152
    buffer_store_dwordx2 v[80:81], v51, s[36:39], s59 offen
    s_mov_b32 s71, 524288
SPL11:
    ds_read_b32 v23, v25 offset:44
    s_waitcnt lgkmcnt(0)
    v_readfirstlane_b32 s70, v23
    s_nop 1
    s_cmp_ge_u32 s70, 4
    s_cbranch_scc1 SPD11
    s_sub_u32 s71, s71, 1
    s_cmp_eq_u32 s71, 0
    s_cbranch_scc1 SPD11
    s_sleep 1
    s_branch SPL11
SPD11:
    s_mov_b32 s71, 524288
SPL12:
    ds_read_b32 v23, v25 offset:60
    s_waitcnt lgkmcnt(0)
    v_readfirstlane_b32 s70, v23
    s_nop 1
    s_cmp_ge_u32 s70, 4
    s_cbranch_scc1 SPD12
    s_sub_u32 s71, s71, 1
    s_cmp_eq_u32 s71, 0
    s_cbranch_scc1 SPD12
    s_sleep 1
    s_branch SPL12
SPD12:
    ds_read_b64_tr_b16 v[104:105], v50 offset:3200
    ds_read_b64_tr_b16 v[106:107], v50 offset:23936
    ds_read_b64_tr_b16 v[108:109], v50 offset:3840
    ds_read_b64_tr_b16 v[110:111], v50 offset:24576
    ds_read_b64_tr_b16 v[112:113], v50 offset:4480
    ds_read_b64_tr_b16 v[114:115], v50 offset:25216
    s_waitcnt lgkmcnt(4)
    v_lshlrev_b32 v34, 16, v101
    v_and_b32 v35, 0xffff0000, v101
    v_lshlrev_b32 v26, 16, v104
    v_and_b32 v27, 0xffff0000, v104
    v_lshlrev_b32 v28, 16, v105
    v_and_b32 v29, 0xffff0000, v105
    v_lshlrev_b32 v30, 16, v106
    v_and_b32 v31, 0xffff0000, v106
    v_lshlrev_b32 v32, 16, v107
    v_and_b32 v33, 0xffff0000, v107
    v_mul_f32 v26, v26, v34
    v_mul_f32 v27, v27, v34
    v_mul_f32 v28, v28, v34
    v_mul_f32 v29, v29, v34
    v_fmac_f32 v26, v30, v35
    v_fmac_f32 v27, v31, v35
    v_fmac_f32 v28, v32, v35
    v_fmac_f32 v29, v33, v35
    v_cvt_pk_bf16_f32 v104, v26, v27
    v_cvt_pk_bf16_f32 v105, v28, v29
    s_mov_b32 s59, 2621440
    buffer_store_dwordx2 v[104:105], v51, s[36:39], s59 offen
    s_waitcnt lgkmcnt(2)
    v_lshlrev_b32 v34, 16, v102
    v_and_b32 v35, 0xffff0000, v102
    v_lshlrev_b32 v26, 16, v108
    v_and_b32 v27, 0xffff0000, v108
    v_lshlrev_b32 v28, 16, v109
    v_and_b32 v29, 0xffff0000, v109
    v_lshlrev_b32 v30, 16, v110
    v_and_b32 v31, 0xffff0000, v110
    v_lshlrev_b32 v32, 16, v111
    v_and_b32 v33, 0xffff0000, v111
    v_mul_f32 v26, v26, v34
    v_mul_f32 v27, v27, v34
    v_mul_f32 v28, v28, v34
    v_mul_f32 v29, v29, v34
    v_fmac_f32 v26, v30, v35
    v_fmac_f32 v27, v31, v35
    v_fmac_f32 v28, v32, v35
    v_fmac_f32 v29, v33, v35
    v_cvt_pk_bf16_f32 v108, v26, v27
    v_cvt_pk_bf16_f32 v109, v28, v29
    s_mov_b32 s59, 3145728
    buffer_store_dwordx2 v[108:109], v51, s[36:39], s59 offen
    s_waitcnt lgkmcnt(0)
    v_lshlrev_b32 v34, 16, v103
    v_and_b32 v35, 0xffff0000, v103
    v_lshlrev_b32 v26, 16, v112
    v_and_b32 v27, 0xffff0000, v112
    v_lshlrev_b32 v28, 16, v113
    v_and_b32 v29, 0xffff0000, v113
    v_lshlrev_b32 v30, 16, v114
    v_and_b32 v31, 0xffff0000, v114
    v_lshlrev_b32 v32, 16, v115
    v_and_b32 v33, 0xffff0000, v115
    v_mul_f32 v26, v26, v34
    v_mul_f32 v27, v27, v34
    v_mul_f32 v28, v28, v34
    v_mul_f32 v29, v29, v34
    v_fmac_f32 v26, v30, v35
    v_fmac_f32 v27, v31, v35
    v_fmac_f32 v28, v32, v35
    v_fmac_f32 v29, v33, v35
    v_cvt_pk_bf16_f32 v112, v26, v27
    v_cvt_pk_bf16_f32 v113, v28, v29
    s_mov_b32 s59, 3670016
    buffer_store_dwordx2 v[112:113], v51, s[36:39], s59 offen
    s_branch KFIN
CONVP:
    s_mul_i32 s67, s48, 8736
    v_lshrrev_b32 v27, 3, v2
    v_mul_u32_u24 v27, 1152, v27
    v_and_b32 v28, 7, v2
    v_lshl_add_u32 v27, v28, 4, v27
    v_add_u32 v27, 4128, v27
    v_and_b32 v28, 1, v2
    v_lshlrev_b32 v28, 4, v28
    v_cmp_gt_u32 vcc, 32, v2
    s_nop 1
    v_cndmask_b32 v27, v28, v27, vcc
    v_add_u32 v8, s67, v27
    v_mov_b32 v16, 0
    v_mov_b32 v17, 0
    v_mov_b32 v18, 0
    v_mov_b32 v19, 0
    ds_write_b128 v8, v[16:19]
    s_waitcnt lgkmcnt(0)
    s_barrier
    s_mov_b64 s[64:65], 1
    v_lshlrev_b32 v6, 4, v2
    v_mov_b32 v25, 69888
    v_mov_b32 v21, 1
    v_cvt_f32_u32 v46, v4
    v_cvt_f32_u32 v47, v4
    s_mov_b32 s52, 0x00010001
    s_mov_b32 s53, 0x00010001
    s_mov_b32 s54, 0xff00ff00
    s_mov_b32 s55, 0xff00ff00
    s_mov_b32 s62, 1069066811
    s_mov_b32 s63, 1042479491
    s_mul_i32 s57, s48, 1280
    s_add_u32 s57, s57, 120192
    v_lshl_add_u32 v32, v2, 4, s57
    s_sub_u32 s58, s57, 0
    v_lshl_add_u32 v40, v5, 6, s58
    s_add_u32 s57, s57, 1024
    v_lshl_add_u32 v33, v2, 2, s57
    v_lshl_add_u32 v41, v5, 4, s57
    s_waitcnt vmcnt(1)
    v_lshlrev_b32 v10, 16, v10
    v_lshlrev_b32 v11, 16, v11
    v_lshlrev_b32 v12, 16, v12
    v_lshlrev_b32 v13, 16, v13
    v_lshlrev_b32 v14, 16, v14
    v_lshlrev_b32 v15, 16, v15
    v_mul_f32 v14, s62, v14
    v_mul_f32 v10, s62, v10
    v_exp_f32 v14, v14
    v_exp_f32 v10, v10
    v_cvt_pk_bf16_f32 v14, v14, v14
    v_cvt_pk_bf16_f32 v10, v10, v10
    v_lshlrev_b32 v14, 16, v14
    v_lshlrev_b32 v10, 16, v10
    v_mul_f32 v28, v10, v14
    v_mul_f32 v29, v11, v14
    v_mul_f32 v28, s62, v28
    v_sub_f32 v28, 0, v28
    v_mul_f32 v29, s63, v29
    v_add_f32 v14, v14, v14
    v_mul_f32 v30, v12, v14
    v_mul_f32 v31, v13, v14
    ds_write_b128 v32, v[28:31]
    s_mov_b32 s58, 0x45000000
    v_mul_f32 v34, s58, v28
    v_mul_f32 v35, s58, v29
    v_exp_f32 v34, v34
    v_fract_f32 v35, v35
    v_cos_f32 v36, v35
    v_sin_f32 v37, v35
    v_mul_f32 v36, v36, v34
    v_mul_f32 v37, v37, v34
    v_mul_f32 v38, v31, v37
    v_mul_f32 v39, v31, v36
    v_fma_f32 v38, v30, v36, -v38
    v_fma_f32 v39, -v30, v37, -v39
    v_cvt_pk_bf16_f32 v38, v38, v39
    ds_write_b32 v33, v38
    s_waitcnt lgkmcnt(0)
    s_mov_b32 s36, s26
    s_and_b32 s37, s27, 0xffff
    s_mov_b32 s38, 4194304
    s_mov_b32 s39, 0x20000
    v_mov_b32 v48, 0
    v_mov_b32 v49, 0
    v_mov_b32 v50, 0
    v_mov_b32 v51, 0
    v_mov_b32 v52, 0
    v_mov_b32 v53, 0
    v_mov_b32 v54, 0
    v_mov_b32 v55, 0
    v_mov_b32 v56, 0
    v_mov_b32 v57, 0
    v_mov_b32 v58, 0
    v_mov_b32 v59, 0
    v_mov_b32 v60, 0
    v_mov_b32 v61, 0
    v_mov_b32 v62, 0
    v_mov_b32 v63, 0
    ds_read_b128 v[64:67], v40 offset:0
    ds_read_b128 v[68:71], v40 offset:16
    ds_read_b128 v[72:75], v40 offset:32
    ds_read_b128 v[76:79], v40 offset:48
    ds_read_b128 v[80:83], v41
    s_mov_b32 s69, 0
KGL:
    v_add_u32 v40, 256, v40
    v_add_u32 v41, 64, v41
    s_waitcnt lgkmcnt(0)
    v_pk_mul_f32 v[100:101], v[64:65], v[46:47]
    v_pk_mul_f32 v[102:103], v[68:69], v[46:47]
    v_pk_mul_f32 v[104:105], v[72:73], v[46:47]
    v_pk_mul_f32 v[106:107], v[76:77], v[46:47]
    v_exp_f32 v100, v100
    v_exp_f32 v102, v102
    v_exp_f32 v104, v104
    v_exp_f32 v106, v106
    v_fract_f32 v101, v101
    v_fract_f32 v103, v103
    v_fract_f32 v105, v105
    v_fract_f32 v107, v107
    v_cos_f32 v84, v101
    v_cos_f32 v86, v103
    v_cos_f32 v88, v105
    v_cos_f32 v90, v107
    v_sin_f32 v85, v101
    v_sin_f32 v87, v103
    v_sin_f32 v89, v105
    v_sin_f32 v91, v107
    v_pk_mul_f32 v[84:85], v[84:85], v[100:101] op_sel:[0,0] op_sel_hi:[1,0]
    v_pk_mul_f32 v[86:87], v[86:87], v[102:103] op_sel:[0,0] op_sel_hi:[1,0]
    v_pk_mul_f32 v[88:89], v[88:89], v[104:105] op_sel:[0,0] op_sel_hi:[1,0]
    v_pk_mul_f32 v[90:91], v[90:91], v[106:107] op_sel:[0,0] op_sel_hi:[1,0]
    v_cvt_pk_bf16_f32 v108, v84, v85
    v_cvt_pk_bf16_f32 v109, v86, v87
    v_cvt_pk_bf16_f32 v110, v88, v89
    v_cvt_pk_bf16_f32 v111, v90, v91
    v_pk_mul_f32 v[100:101], v[84:85], v[84:85] op_sel:[0,0] op_sel_hi:[0,1]
    v_pk_mul_f32 v[102:103], v[86:87], v[86:87] op_sel:[0,0] op_sel_hi:[0,1]
    v_pk_mul_f32 v[104:105], v[88:89], v[88:89] op_sel:[0,0] op_sel_hi:[0,1]
    v_pk_mul_f32 v[106:107], v[90:91], v[90:91] op_sel:[0,0] op_sel_hi:[0,1]
    v_pk_fma_f32 v[84:85], v[84:85], v[84:85], v[100:101] op_sel:[1,1,0] op_sel_hi:[0,1,1] neg_lo:[1,0,0]
    v_pk_fma_f32 v[86:87], v[86:87], v[86:87], v[102:103] op_sel:[1,1,0] op_sel_hi:[0,1,1] neg_lo:[1,0,0]
    v_pk_fma_f32 v[88:89], v[88:89], v[88:89], v[104:105] op_sel:[1,1,0] op_sel_hi:[0,1,1] neg_lo:[1,0,0]
    v_pk_fma_f32 v[90:91], v[90:91], v[90:91], v[106:107] op_sel:[1,1,0] op_sel_hi:[0,1,1] neg_lo:[1,0,0]
    v_cvt_pk_bf16_f32 v112, v84, v85
    v_cvt_pk_bf16_f32 v113, v86, v87
    v_cvt_pk_bf16_f32 v114, v88, v89
    v_cvt_pk_bf16_f32 v115, v90, v91
    v_pk_mul_f32 v[100:101], v[84:85], v[84:85] op_sel:[0,0] op_sel_hi:[0,1]
    v_pk_mul_f32 v[102:103], v[86:87], v[86:87] op_sel:[0,0] op_sel_hi:[0,1]
    v_pk_mul_f32 v[104:105], v[88:89], v[88:89] op_sel:[0,0] op_sel_hi:[0,1]
    v_pk_mul_f32 v[106:107], v[90:91], v[90:91] op_sel:[0,0] op_sel_hi:[0,1]
    v_pk_fma_f32 v[84:85], v[84:85], v[84:85], v[100:101] op_sel:[1,1,0] op_sel_hi:[0,1,1] neg_lo:[1,0,0]
    v_pk_fma_f32 v[86:87], v[86:87], v[86:87], v[102:103] op_sel:[1,1,0] op_sel_hi:[0,1,1] neg_lo:[1,0,0]
    v_pk_fma_f32 v[88:89], v[88:89], v[88:89], v[104:105] op_sel:[1,1,0] op_sel_hi:[0,1,1] neg_lo:[1,0,0]
    v_pk_fma_f32 v[90:91], v[90:91], v[90:91], v[106:107] op_sel:[1,1,0] op_sel_hi:[0,1,1] neg_lo:[1,0,0]
    v_cvt_pk_bf16_f32 v116, v84, v85
    v_cvt_pk_bf16_f32 v117, v86, v87
    v_cvt_pk_bf16_f32 v118, v88, v89
    v_cvt_pk_bf16_f32 v119, v90, v91
    v_pk_mul_f32 v[100:101], v[84:85], v[84:85] op_sel:[0,0] op_sel_hi:[0,1]
    v_pk_mul_f32 v[102:103], v[86:87], v[86:87] op_sel:[0,0] op_sel_hi:[0,1]
    v_pk_mul_f32 v[104:105], v[88:89], v[88:89] op_sel:[0,0] op_sel_hi:[0,1]
    v_pk_mul_f32 v[106:107], v[90:91], v[90:91] op_sel:[0,0] op_sel_hi:[0,1]
    v_pk_fma_f32 v[84:85], v[84:85], v[84:85], v[100:101] op_sel:[1,1,0] op_sel_hi:[0,1,1] neg_lo:[1,0,0]
    v_pk_fma_f32 v[86:87], v[86:87], v[86:87], v[102:103] op_sel:[1,1,0] op_sel_hi:[0,1,1] neg_lo:[1,0,0]
    v_pk_fma_f32 v[88:89], v[88:89], v[88:89], v[104:105] op_sel:[1,1,0] op_sel_hi:[0,1,1] neg_lo:[1,0,0]
    v_pk_fma_f32 v[90:91], v[90:91], v[90:91], v[106:107] op_sel:[1,1,0] op_sel_hi:[0,1,1] neg_lo:[1,0,0]
    v_cvt_pk_bf16_f32 v120, v84, v85
    v_cvt_pk_bf16_f32 v121, v86, v87
    v_cvt_pk_bf16_f32 v122, v88, v89
    v_cvt_pk_bf16_f32 v123, v90, v91
    v_pk_mul_f32 v[100:101], v[84:85], v[84:85] op_sel:[0,0] op_sel_hi:[0,1]
    v_pk_mul_f32 v[102:103], v[86:87], v[86:87] op_sel:[0,0] op_sel_hi:[0,1]
    v_pk_mul_f32 v[104:105], v[88:89], v[88:89] op_sel:[0,0] op_sel_hi:[0,1]
    v_pk_mul_f32 v[106:107], v[90:91], v[90:91] op_sel:[0,0] op_sel_hi:[0,1]
    v_pk_fma_f32 v[84:85], v[84:85], v[84:85], v[100:101] op_sel:[1,1,0] op_sel_hi:[0,1,1] neg_lo:[1,0,0]
    v_pk_fma_f32 v[86:87], v[86:87], v[86:87], v[102:103] op_sel:[1,1,0] op_sel_hi:[0,1,1] neg_lo:[1,0,0]
    v_pk_fma_f32 v[88:89], v[88:89], v[88:89], v[104:105] op_sel:[1,1,0] op_sel_hi:[0,1,1] neg_lo:[1,0,0]
    v_pk_fma_f32 v[90:91], v[90:91], v[90:91], v[106:107] op_sel:[1,1,0] op_sel_hi:[0,1,1] neg_lo:[1,0,0]
    v_pk_mul_f32 v[100:101], v[66:67], v[84:85] op_sel:[1,1] op_sel_hi:[1,0]
    v_pk_mul_f32 v[102:103], v[70:71], v[86:87] op_sel:[1,1] op_sel_hi:[1,0]
    v_pk_mul_f32 v[104:105], v[74:75], v[88:89] op_sel:[1,1] op_sel_hi:[1,0]
    v_pk_mul_f32 v[106:107], v[78:79], v[90:91] op_sel:[1,1] op_sel_hi:[1,0]
    v_pk_fma_f32 v[92:93], v[66:67], v[84:85], v[100:101] op_sel:[0,0,0] op_sel_hi:[0,1,1] neg_lo:[0,0,1] neg_hi:[1,0,1]
    v_pk_fma_f32 v[94:95], v[70:71], v[86:87], v[102:103] op_sel:[0,0,0] op_sel_hi:[0,1,1] neg_lo:[0,0,1] neg_hi:[1,0,1]
    v_pk_fma_f32 v[96:97], v[74:75], v[88:89], v[104:105] op_sel:[0,0,0] op_sel_hi:[0,1,1] neg_lo:[0,0,1] neg_hi:[1,0,1]
    v_pk_fma_f32 v[98:99], v[78:79], v[90:91], v[106:107] op_sel:[0,0,0] op_sel_hi:[0,1,1] neg_lo:[0,0,1] neg_hi:[1,0,1]
    v_cvt_pk_bf16_f32 v124, v92, v93
    v_cvt_pk_bf16_f32 v125, v94, v95
    v_cvt_pk_bf16_f32 v126, v96, v97
    v_cvt_pk_bf16_f32 v127, v98, v99
    v_pk_mul_f32 v[100:101], v[92:93], v[84:85] op_sel:[0,0] op_sel_hi:[1,0]
    v_pk_mul_f32 v[102:103], v[94:95], v[86:87] op_sel:[0,0] op_sel_hi:[1,0]
    v_pk_mul_f32 v[104:105], v[96:97], v[88:89] op_sel:[0,0] op_sel_hi:[1,0]
    v_pk_mul_f32 v[106:107], v[98:99], v[90:91] op_sel:[0,0] op_sel_hi:[1,0]
    v_pk_fma_f32 v[92:93], v[92:93], v[84:85], v[100:101] op_sel:[1,1,0] op_sel_hi:[0,1,1] neg_hi:[1,0,0]
    v_pk_fma_f32 v[94:95], v[94:95], v[86:87], v[102:103] op_sel:[1,1,0] op_sel_hi:[0,1,1] neg_hi:[1,0,0]
    v_pk_fma_f32 v[96:97], v[96:97], v[88:89], v[104:105] op_sel:[1,1,0] op_sel_hi:[0,1,1] neg_hi:[1,0,0]
    v_pk_fma_f32 v[98:99], v[98:99], v[90:91], v[106:107] op_sel:[1,1,0] op_sel_hi:[0,1,1] neg_hi:[1,0,0]
    v_cvt_pk_bf16_f32 v128, v92, v93
    v_cvt_pk_bf16_f32 v129, v94, v95
    v_cvt_pk_bf16_f32 v130, v96, v97
    v_cvt_pk_bf16_f32 v131, v98, v99
    v_pk_mul_f32 v[100:101], v[84:85], v[84:85] op_sel:[0,0] op_sel_hi:[0,1]
    v_pk_mul_f32 v[102:103], v[86:87], v[86:87] op_sel:[0,0] op_sel_hi:[0,1]
    v_pk_mul_f32 v[104:105], v[88:89], v[88:89] op_sel:[0,0] op_sel_hi:[0,1]
    v_pk_mul_f32 v[106:107], v[90:91], v[90:91] op_sel:[0,0] op_sel_hi:[0,1]
    v_pk_fma_f32 v[84:85], v[84:85], v[84:85], v[100:101] op_sel:[1,1,0] op_sel_hi:[0,1,1] neg_lo:[1,0,0]
    v_pk_fma_f32 v[86:87], v[86:87], v[86:87], v[102:103] op_sel:[1,1,0] op_sel_hi:[0,1,1] neg_lo:[1,0,0]
    v_pk_fma_f32 v[88:89], v[88:89], v[88:89], v[104:105] op_sel:[1,1,0] op_sel_hi:[0,1,1] neg_lo:[1,0,0]
    v_pk_fma_f32 v[90:91], v[90:91], v[90:91], v[106:107] op_sel:[1,1,0] op_sel_hi:[0,1,1] neg_lo:[1,0,0]
    v_pk_mul_f32 v[100:101], v[92:93], v[84:85] op_sel:[0,0] op_sel_hi:[1,0]
    v_pk_mul_f32 v[102:103], v[94:95], v[86:87] op_sel:[0,0] op_sel_hi:[1,0]
    v_pk_mul_f32 v[104:105], v[96:97], v[88:89] op_sel:[0,0] op_sel_hi:[1,0]
    v_pk_mul_f32 v[106:107], v[98:99], v[90:91] op_sel:[0,0] op_sel_hi:[1,0]
    v_pk_fma_f32 v[92:93], v[92:93], v[84:85], v[100:101] op_sel:[1,1,0] op_sel_hi:[0,1,1] neg_hi:[1,0,0]
    v_pk_fma_f32 v[94:95], v[94:95], v[86:87], v[102:103] op_sel:[1,1,0] op_sel_hi:[0,1,1] neg_hi:[1,0,0]
    v_pk_fma_f32 v[96:97], v[96:97], v[88:89], v[104:105] op_sel:[1,1,0] op_sel_hi:[0,1,1] neg_hi:[1,0,0]
    v_pk_fma_f32 v[98:99], v[98:99], v[90:91], v[106:107] op_sel:[1,1,0] op_sel_hi:[0,1,1] neg_hi:[1,0,0]
    v_cvt_pk_bf16_f32 v132, v92, v93
    v_cvt_pk_bf16_f32 v133, v94, v95
    v_cvt_pk_bf16_f32 v134, v96, v97
    v_cvt_pk_bf16_f32 v135, v98, v99
    v_pk_mul_f32 v[100:101], v[84:85], v[84:85] op_sel:[0,0] op_sel_hi:[0,1]
    v_pk_mul_f32 v[102:103], v[86:87], v[86:87] op_sel:[0,0] op_sel_hi:[0,1]
    v_pk_mul_f32 v[104:105], v[88:89], v[88:89] op_sel:[0,0] op_sel_hi:[0,1]
    v_pk_mul_f32 v[106:107], v[90:91], v[90:91] op_sel:[0,0] op_sel_hi:[0,1]
    v_pk_fma_f32 v[84:85], v[84:85], v[84:85], v[100:101] op_sel:[1,1,0] op_sel_hi:[0,1,1] neg_lo:[1,0,0]
    v_pk_fma_f32 v[86:87], v[86:87], v[86:87], v[102:103] op_sel:[1,1,0] op_sel_hi:[0,1,1] neg_lo:[1,0,0]
    v_pk_fma_f32 v[88:89], v[88:89], v[88:89], v[104:105] op_sel:[1,1,0] op_sel_hi:[0,1,1] neg_lo:[1,0,0]
    v_pk_fma_f32 v[90:91], v[90:91], v[90:91], v[106:107] op_sel:[1,1,0] op_sel_hi:[0,1,1] neg_lo:[1,0,0]
    v_pk_mul_f32 v[100:101], v[92:93], v[84:85] op_sel:[0,0] op_sel_hi:[1,0]
    v_pk_mul_f32 v[102:103], v[94:95], v[86:87] op_sel:[0,0] op_sel_hi:[1,0]
    v_pk_mul_f32 v[104:105], v[96:97], v[88:89] op_sel:[0,0] op_sel_hi:[1,0]
    v_pk_mul_f32 v[106:107], v[98:99], v[90:91] op_sel:[0,0] op_sel_hi:[1,0]
    v_pk_fma_f32 v[92:93], v[92:93], v[84:85], v[100:101] op_sel:[1,1,0] op_sel_hi:[0,1,1] neg_hi:[1,0,0]
    v_pk_fma_f32 v[94:95], v[94:95], v[86:87], v[102:103] op_sel:[1,1,0] op_sel_hi:[0,1,1] neg_hi:[1,0,0]
    v_pk_fma_f32 v[96:97], v[96:97], v[88:89], v[104:105] op_sel:[1,1,0] op_sel_hi:[0,1,1] neg_hi:[1,0,0]
    v_pk_fma_f32 v[98:99], v[98:99], v[90:91], v[106:107] op_sel:[1,1,0] op_sel_hi:[0,1,1] neg_hi:[1,0,0]
    v_cvt_pk_bf16_f32 v136, v92, v93
    v_cvt_pk_bf16_f32 v137, v94, v95
    v_cvt_pk_bf16_f32 v138, v96, v97
    v_cvt_pk_bf16_f32 v139, v98, v99
    v_cndmask_b32 v136, v136, v80, s[52:53]
    v_cndmask_b32 v137, v137, v81, s[52:53]
    v_cndmask_b32 v138, v138, v82, s[52:53]
    v_cndmask_b32 v139, v139, v83, s[52:53]
    ds_read_b128 v[64:67], v40 offset:0
    ds_read_b128 v[68:71], v40 offset:16
    ds_read_b128 v[72:75], v40 offset:32
    ds_read_b128 v[76:79], v40 offset:48
    ds_read_b128 v[80:83], v41
    v_mfma_f32_16x16x32_bf16 v[48:51], v[108:111], v[124:127], v[48:51]
    v_mfma_f32_16x16x32_bf16 v[52:55], v[112:115], v[128:131], v[52:55]
    v_mfma_f32_16x16x32_bf16 v[56:59], v[116:119], v[132:135], v[56:59]
    v_mfma_f32_16x16x32_bf16 v[60:63], v[120:123], v[136:139], v[60:63]
    s_lshl_b32 s57, s50, 2
    s_add_u32 s57, s57, s69
    s_cmp_lg_u32 s57, 6
    s_cbranch_scc1 NOSK
    s_lshl_b32 s62, s31, 12
    s_add_u32 m0, s67, 32
    s_add_u32 s63, s62, 0
    buffer_load_dwordx4 v6, s[36:39], s63 offen lds
    s_add_u32 m0, s67, 1056
    s_add_u32 s63, s62, 1024
    buffer_load_dwordx4 v6, s[36:39], s63 offen lds
    s_add_u32 m0, s67, 2080
    s_add_u32 s63, s62, 2048
    buffer_load_dwordx4 v6, s[36:39], s63 offen lds
    s_add_u32 m0, s67, 3104
    s_add_u32 s63, s62, 3072
    buffer_load_dwordx4 v6, s[36:39], s63 offen lds
NOSK:
    s_add_u32 s69, s69, 1
    s_cmp_lt_u32 s69, 4
    s_cbranch_scc1 KGL
    s_waitcnt lgkmcnt(0)
    s_lshl_b32 s57, s49, 12
    s_add_u32 s57, s57, 130432
    v_lshl_add_u32 v40, v2, 4, s57
    s_lshl_b32 s57, s49, 2
    v_add_u32 v41, s57, v25
    s_nop 7
    s_cmp_eq_u32 s50, 0
    s_cbranch_scc1 AEXP
    ds_write_b128 v40, v[48:51] offset:0
    ds_write_b128 v40, v[52:55] offset:1024
    ds_write_b128 v40, v[56:59] offset:2048
    ds_write_b128 v40, v[60:63] offset:3072
    s_waitcnt lgkmcnt(0)
    s_mov_b64 exec, 1
    ds_add_u32 v41, v21 offset:72
    s_mov_b64 exec, -1
    s_waitcnt vmcnt(0)
    s_add_u32 s57, s67, 32
    v_mov_b32 v10, s57
    ds_read_u16 v11, v10
    s_waitcnt lgkmcnt(0)
    v_lshlrev_b32 v11, 16, v11
    v_lshlrev_b32 v9, 16, v9
    v_add_f32 v11, v11, v9
    v_cvt_pk_bf16_f32 v11, v11, v11
    ds_write_b16 v10, v11
    s_branch CSET
AEXP:
    s_mov_b32 s71, 524288
SPL13:
    ds_read_b32 v42, v41 offset:72
    s_waitcnt lgkmcnt(0)
    v_readfirstlane_b32 s70, v42
    s_nop 1
    s_cmp_ge_u32 s70, 1
    s_cbranch_scc1 SPD13
    s_sub_u32 s71, s71, 1
    s_cmp_eq_u32 s71, 0
    s_cbranch_scc1 SPD13
    s_sleep 1
    s_branch SPL13
SPD13:
    ds_read_b128 v[64:67], v40 offset:0
    ds_read_b128 v[68:71], v40 offset:1024
    ds_read_b128 v[72:75], v40 offset:2048
    ds_read_b128 v[76:79], v40 offset:3072
    s_waitcnt lgkmcnt(0)
    v_add_f32 v48, v48, v64
    v_add_f32 v49, v49, v65
    v_add_f32 v50, v50, v66
    v_add_f32 v51, v51, v67
    v_add_f32 v52, v52, v68
    v_add_f32 v53, v53, v69
    v_add_f32 v54, v54, v70
    v_add_f32 v55, v55, v71
    v_add_f32 v56, v56, v72
    v_add_f32 v57, v57, v73
    v_add_f32 v58, v58, v74
    v_add_f32 v59, v59, v75
    v_add_f32 v60, v60, v76
    v_add_f32 v61, v61, v77
    v_add_f32 v62, v62, v78
    v_add_f32 v63, v63, v79
    v_mov_b32 v84, 0
    v_cndmask_b32 v84, v84, v15, s[64:65]
    v_add_f32 v48, v48, v84
    s_add_u32 s57, s67, 32
    v_mov_b32 v85, s57
    v_lshlrev_b32 v96, 4, v4
    v_lshl_add_u32 v96, v5, 2, v96
    v_cvt_pk_bf16_f32 v88, v60, v60
    v_cvt_pk_bf16_f32 v89, v60, v61
    v_cvt_pk_bf16_f32 v90, v61, v61
    v_cvt_pk_bf16_f32 v91, v62, v62
    v_cvt_pk_bf16_f32 v92, v62, v63
    v_cvt_pk_bf16_f32 v93, v63, v63
    v_cvt_pk_bf16_f32 v94, v61, v62
    s_mov_b64 exec, 1
    v_add_u32 v97, 4088, v85
    ds_write2_b32 v97, v88, v88 offset0:0 offset1:1
    s_mov_b64 exec, s[54:55]
    v_lshlrev_b32 v95, 4, v96
    v_add3_u32 v95, v95, v85, -8
    ds_write2_b32 v95, v88, v88 offset0:0 offset1:1
    ds_write2_b32 v95, v88, v88 offset0:2 offset1:3
    ds_write2_b32 v95, v89, v90 offset0:4 offset1:5
    ds_write2_b32 v95, v90, v90 offset0:6 offset1:7
    ds_write2_b32 v95, v91, v91 offset0:8 offset1:9
    ds_write2_b32 v95, v91, v91 offset0:10 offset1:11
    ds_write2_b32 v95, v92, v93 offset0:12 offset1:13
    ds_write2_b32 v95, v93, v93 offset0:14 offset1:15
    v_cvt_pk_bf16_f32 v88, v56, v56
    v_cvt_pk_bf16_f32 v89, v56, v57
    v_cvt_pk_bf16_f32 v90, v57, v57
    v_cvt_pk_bf16_f32 v91, v58, v58
    v_cvt_pk_bf16_f32 v92, v58, v59
    v_cvt_pk_bf16_f32 v93, v59, v59
    v_cvt_pk_bf16_f32 v94, v57, v58
    v_lshlrev_b32 v95, 3, v96
    v_add3_u32 v95, v95, v85, -4
    ds_write2_b32 v95, v88, v88 offset0:0 offset1:1
    ds_write2_b32 v95, v89, v90 offset0:2 offset1:3
    ds_write2_b32 v95, v91, v91 offset0:4 offset1:5
    ds_write2_b32 v95, v92, v93 offset0:6 offset1:7
    v_cvt_pk_bf16_f32 v88, v52, v52
    v_cvt_pk_bf16_f32 v89, v52, v53
    v_cvt_pk_bf16_f32 v90, v53, v53
    v_cvt_pk_bf16_f32 v91, v54, v54
    v_cvt_pk_bf16_f32 v92, v54, v55
    v_cvt_pk_bf16_f32 v93, v55, v55
    v_cvt_pk_bf16_f32 v94, v53, v54
    v_lshlrev_b32 v95, 2, v96
    v_add3_u32 v95, v95, v85, -4
    ds_write_b16 v95, v88 offset:2
    ds_write2_b32 v95, v88, v94 offset0:1 offset1:2
    ds_write_b32 v95, v91 offset:12
    ds_write_b16 v95, v93 offset:16
    s_mov_b64 exec, -1
    v_cvt_pk_bf16_f32 v88, v48, v48
    v_cvt_pk_bf16_f32 v89, v48, v49
    v_cvt_pk_bf16_f32 v90, v49, v49
    v_cvt_pk_bf16_f32 v91, v50, v50
    v_cvt_pk_bf16_f32 v92, v50, v51
    v_cvt_pk_bf16_f32 v93, v51, v51
    v_cvt_pk_bf16_f32 v94, v49, v50
    v_lshlrev_b32 v95, 1, v96
    v_add_u32 v95, v95, v85
    ds_write2_b32 v95, v89, v92 offset0:0 offset1:1
CSET:
    v_lshrrev_b32 v10, 2, v4
    v_and_b32 v11, 3, v2
    v_sub_u32 v11, v11, v10
    v_lshlrev_b32 v11, 3, v11
    v_lshlrev_b32 v10, 6, v5
    v_sub_u32 v11, v11, v10
    s_add_u32 s59, s67, 224
    v_add_u32 v16, s59, v11
    v_lshlrev_b32 v10, 3, v4
    v_lshl_add_u32 v10, v5, 4, v10
    s_add_u32 s59, s67, 4136
    v_add_u32 v17, s59, v10
    v_add_u32 v10, -1, v4
    v_and_b32 v10, 15, v10
    v_add_u32 v10, 48, v10
    v_add_u32 v11, -16, v2
    v_cmp_gt_u32 vcc, 16, v2
    s_nop 1
    v_cndmask_b32 v10, v11, v10, vcc
    v_lshlrev_b32 v18, 2, v10
    v_mov_b32 v19, 0
    s_mul_i32 s59, s49, 5184
    s_mul_i32 s60, s50, 20736
    s_add_u32 s59, s59, s60
    s_add_u32 s59, s59, 70016
    v_mul_u32_u24 v10, 40, v4
    v_lshl_add_u32 v10, v5, 3, v10
    v_add_u32 v20, s59, v10
    s_mul_i32 s59, s49, 8736
    s_add_u32 s59, s59, 4256
    v_lshlrev_b32 v10, 3, v4
    v_lshl_add_u32 v10, v5, 1, v10
    v_add_u32 v22, s59, v10
    s_lshl_b32 s59, s50, 4
    v_add_u32 v24, s59, v25
    s_lshl_b32 s59, s50, 2
    v_subrev_u32 v26, s59, v25
    s_cmp_eq_u32 s50, 0
    s_cbranch_scc1 CONVS
    s_setprio 1
CONVS:
    s_waitcnt lgkmcnt(0)
    ds_read_b64_tr_b16 v[36:37], v16 offset:288
    ds_read_b64_tr_b16 v[38:39], v16 offset:256
    ds_read_b64_tr_b16 v[44:45], v16 offset:800
    ds_read_b64_tr_b16 v[46:47], v16 offset:768
    ds_read_b64_tr_b16 v[52:53], v16 offset:1312
    ds_read_b64_tr_b16 v[54:55], v16 offset:1280
    ds_read_b64_tr_b16 v[60:61], v16 offset:1824
    ds_read_b64_tr_b16 v[62:63], v16 offset:1792
    ds_read_b64_tr_b16 v[68:69], v16 offset:2336
    ds_read_b64_tr_b16 v[70:71], v16 offset:2304
    ds_read_b64_tr_b16 v[32:33], v16 offset:32
    ds_read_b64_tr_b16 v[34:35], v16 offset:0
    ds_read_b64_tr_b16 v[40:41], v16 offset:544
    ds_read_b64_tr_b16 v[42:43], v16 offset:512
    s_waitcnt lgkmcnt(8)
    ds_read_b64_tr_b16 v[48:49], v16 offset:1056
    ds_read_b64_tr_b16 v[50:51], v16 offset:1024
    ds_read_b64_tr_b16 v[56:57], v16 offset:1568
    ds_read_b64_tr_b16 v[58:59], v16 offset:1536
    ds_read_b64_tr_b16 v[64:65], v16 offset:2080
    ds_read_b64_tr_b16 v[66:67], v16 offset:2048
    s_waitcnt lgkmcnt(8)
    ds_read_b64_tr_b16 v[76:77], v16 offset:2848
    ds_read_b64_tr_b16 v[78:79], v16 offset:2816
    ds_read_b64_tr_b16 v[84:85], v16 offset:3360
    ds_read_b64_tr_b16 v[86:87], v16 offset:3328
    ds_read_b64_tr_b16 v[92:93], v16 offset:3872
    ds_read_b64_tr_b16 v[94:95], v16 offset:3840
    s_waitcnt lgkmcnt(8)
    ds_read_b64_tr_b16 v[72:73], v16 offset:2592
    ds_read_b64_tr_b16 v[74:75], v16 offset:2560
    ds_read_b64_tr_b16 v[80:81], v16 offset:3104
    ds_read_b64_tr_b16 v[82:83], v16 offset:3072
    ds_read_b64_tr_b16 v[88:89], v16 offset:3616
    ds_read_b64_tr_b16 v[90:91], v16 offset:3584
    s_waitcnt lgkmcnt(8)
    s_waitcnt lgkmcnt(0)
    s_mov_b32 s71, 524288
SPL14:
    ds_read_b32 v23, v26 offset:28
    s_waitcnt lgkmcnt(0)
    v_readfirstlane_b32 s70, v23
    s_nop 1
    s_cmp_ge_u32 s70, 4
    s_cbranch_scc1 SPD14
    s_sub_u32 s71, s71, 1
    s_cmp_eq_u32 s71, 0
    s_cbranch_scc1 SPD14
    s_sleep 1
    s_branch SPL14
SPD14:
    ds_read_b64 v[116:117], v17 offset:3456
    ds_read_b64 v[118:119], v17 offset:3464
    ds_read_b64 v[120:121], v17 offset:3520
    ds_read_b64 v[122:123], v17 offset:3528
    s_waitcnt lgkmcnt(2)
    v_mfma_f32_16x16x32_bf16 v[96:99], v[36:39], v[116:119], 0
    ds_read_b64 v[124:125], v17 offset:3584
    ds_read_b64 v[126:127], v17 offset:3592
    v_mfma_f32_16x16x32_bf16 v[100:103], v[44:47], v[116:119], 0
    ds_read_b64 v[128:129], v17 offset:3648
    ds_read_b64 v[130:131], v17 offset:3656
    v_mfma_f32_16x16x32_bf16 v[104:107], v[52:55], v[116:119], 0
    ds_read_b64 v[132:133], v17 offset:3712
    ds_read_b64 v[134:135], v17 offset:3720
    v_mfma_f32_16x16x32_bf16 v[108:111], v[60:63], v[116:119], 0
    ds_read_b64 v[136:137], v17 offset:3776
    ds_read_b64 v[138:139], v17 offset:3784
    v_mfma_f32_16x16x32_bf16 v[112:115], v[68:71], v[116:119], 0
    s_waitcnt lgkmcnt(8)
    v_mfma_f32_16x16x32_bf16 v[96:99], v[32:35], v[120:123], v[96:99]
    ds_read_b64 v[116:117], v17 offset:3840
    ds_read_b64 v[118:119], v17 offset:3848
    v_mfma_f32_16x16x32_bf16 v[100:103], v[40:43], v[120:123], v[100:103]
    v_mfma_f32_16x16x32_bf16 v[104:107], v[48:51], v[120:123], v[104:107]
    v_mfma_f32_16x16x32_bf16 v[108:111], v[56:59], v[120:123], v[108:111]
    v_mfma_f32_16x16x32_bf16 v[112:115], v[64:67], v[120:123], v[112:115]
    s_waitcnt lgkmcnt(8)
    v_mfma_f32_16x16x32_bf16 v[100:103], v[36:39], v[124:127], v[100:103]
    ds_read_b64 v[120:121], v17 offset:3904
    ds_read_b64 v[122:123], v17 offset:3912
    v_mfma_f32_16x16x32_bf16 v[104:107], v[44:47], v[124:127], v[104:107]
    ds_bpermute_b32 v140, v18, v99
    v_mfma_f32_16x16x32_bf16 v[108:111], v[52:55], v[124:127], v[108:111]
    v_mfma_f32_16x16x32_bf16 v[112:115], v[60:63], v[124:127], v[112:115]
    s_waitcnt lgkmcnt(9)
    v_mfma_f32_16x16x32_bf16 v[100:103], v[32:35], v[128:131], v[100:103]
    ds_read_b64 v[124:125], v17 offset:3968
    ds_read_b64 v[126:127], v17 offset:3976
    v_mfma_f32_16x16x32_bf16 v[104:107], v[40:43], v[128:131], v[104:107]
    v_mfma_f32_16x16x32_bf16 v[108:111], v[48:51], v[128:131], v[108:111]
    v_mfma_f32_16x16x32_bf16 v[112:115], v[56:59], v[128:131], v[112:115]
    s_waitcnt lgkmcnt(2)
    v_mov_b32 v99, v98
    v_mov_b32 v98, v97
    v_mov_b32 v97, v96
    v_cndmask_b32 v96, v140, v19, s[64:65]
    v_mfma_f32_16x16x32_bf16 v[104:107], v[36:39], v[132:135], v[104:107]
    ds_read_b64 v[128:129], v17 offset:4032
    ds_read_b64 v[130:131], v17 offset:4040
    v_mfma_f32_16x16x32_bf16 v[108:111], v[44:47], v[132:135], v[108:111]
    v_mfma_f32_16x16x32_bf16 v[112:115], v[52:55], v[132:135], v[112:115]
    ds_bpermute_b32 v141, v18, v103
    v_mfma_f32_16x16x32_bf16 v[104:107], v[32:35], v[136:139], v[104:107]
    ds_read_b64 v[132:133], v17 offset:2304
    ds_read_b64 v[134:135], v17 offset:2312
    v_mfma_f32_16x16x32_bf16 v[108:111], v[40:43], v[136:139], v[108:111]
    v_mfma_f32_16x16x32_bf16 v[112:115], v[48:51], v[136:139], v[112:115]
    v_mfma_f32_16x16x32_bf16 v[108:111], v[36:39], v[116:119], v[108:111]
    ds_read_b64 v[136:137], v17 offset:2368
    ds_read_b64 v[138:139], v17 offset:2376
    v_mfma_f32_16x16x32_bf16 v[112:115], v[44:47], v[116:119], v[112:115]
    v_mfma_f32_16x16x32_bf16 v[108:111], v[32:35], v[120:123], v[108:111]
    s_waitcnt lgkmcnt(4)
    v_mov_b32 v103, v102
    v_mov_b32 v102, v101
    v_mov_b32 v101, v100
    v_cndmask_b32 v100, v141, v140, s[64:65]
    ds_read_b64 v[116:117], v17 offset:2432
    ds_read_b64 v[118:119], v17 offset:2440
    v_mfma_f32_16x16x32_bf16 v[112:115], v[40:43], v[120:123], v[112:115]
    ds_bpermute_b32 v142, v18, v107
    v_mfma_f32_16x16x32_bf16 v[112:115], v[36:39], v[124:127], v[112:115]
    ds_read_b64 v[120:121], v17 offset:2496
    ds_read_b64 v[122:123], v17 offset:2504
    v_mfma_f32_16x16x32_bf16 v[112:115], v[32:35], v[128:131], v[112:115]
    ds_read_b64 v[124:125], v17 offset:2560
    ds_read_b64 v[126:127], v17 offset:2568
    s_waitcnt lgkmcnt(9)
    v_mfma_f32_16x16x32_bf16 v[96:99], v[36:39], v[132:135], v[96:99]
    ds_read_b64 v[128:129], v17 offset:2624
    ds_read_b64 v[130:131], v17 offset:2632
    v_mfma_f32_16x16x32_bf16 v[100:103], v[44:47], v[132:135], v[100:103]
    s_waitcnt lgkmcnt(6)
    v_mov_b32 v107, v106
    v_mov_b32 v106, v105
    v_mov_b32 v105, v104
    v_cndmask_b32 v104, v142, v141, s[64:65]
    s_nop 1
    v_mfma_f32_16x16x32_bf16 v[104:107], v[52:55], v[132:135], v[104:107]
    ds_bpermute_b32 v143, v18, v111
    s_waitcnt lgkmcnt(0)
    v_mov_b32 v111, v110
    v_mov_b32 v110, v109
    v_mov_b32 v109, v108
    v_cndmask_b32 v108, v143, v142, s[64:65]
    s_nop 1
    v_mfma_f32_16x16x32_bf16 v[108:111], v[60:63], v[132:135], v[108:111]
    ds_bpermute_b32 v148, v18, v115
    s_waitcnt lgkmcnt(0)
    v_mov_b32 v115, v114
    v_mov_b32 v114, v113
    v_mov_b32 v113, v112
    v_cndmask_b32 v112, v148, v143, s[64:65]
    s_nop 1
    v_mfma_f32_16x16x32_bf16 v[112:115], v[68:71], v[132:135], v[112:115]
    v_mfma_f32_16x16x32_bf16 v[96:99], v[32:35], v[136:139], v[96:99]
    ds_read_b64 v[132:133], v17 offset:2688
    ds_read_b64 v[134:135], v17 offset:2696
    v_mfma_f32_16x16x32_bf16 v[100:103], v[40:43], v[136:139], v[100:103]
    v_mfma_f32_16x16x32_bf16 v[104:107], v[48:51], v[136:139], v[104:107]
    v_mfma_f32_16x16x32_bf16 v[108:111], v[56:59], v[136:139], v[108:111]
    v_mfma_f32_16x16x32_bf16 v[112:115], v[64:67], v[136:139], v[112:115]
    v_mfma_f32_16x16x32_bf16 v[100:103], v[36:39], v[116:119], v[100:103]
    ds_read_b64 v[136:137], v17 offset:2752
    ds_read_b64 v[138:139], v17 offset:2760
    v_mfma_f32_16x16x32_bf16 v[104:107], v[44:47], v[116:119], v[104:107]
    ds_bpermute_b32 v140, v18, v99
    v_mfma_f32_16x16x32_bf16 v[108:111], v[52:55], v[116:119], v[108:111]
    v_mfma_f32_16x16x32_bf16 v[112:115], v[60:63], v[116:119], v[112:115]
    v_mfma_f32_16x16x32_bf16 v[100:103], v[32:35], v[120:123], v[100:103]
    ds_read_b64 v[116:117], v17 offset:2816
    ds_read_b64 v[118:119], v17 offset:2824
    v_mfma_f32_16x16x32_bf16 v[104:107], v[40:43], v[120:123], v[104:107]
    v_mfma_f32_16x16x32_bf16 v[108:111], v[48:51], v[120:123], v[108:111]
    v_mfma_f32_16x16x32_bf16 v[112:115], v[56:59], v[120:123], v[112:115]
    s_waitcnt lgkmcnt(2)
    v_mov_b32 v99, v98
    v_mov_b32 v98, v97
    v_mov_b32 v97, v96
    v_cndmask_b32 v96, v140, v19, s[64:65]
    v_mfma_f32_16x16x32_bf16 v[104:107], v[36:39], v[124:127], v[104:107]
    ds_read_b64 v[120:121], v17 offset:2880
    ds_read_b64 v[122:123], v17 offset:2888
    v_mfma_f32_16x16x32_bf16 v[108:111], v[44:47], v[124:127], v[108:111]
    v_mfma_f32_16x16x32_bf16 v[112:115], v[52:55], v[124:127], v[112:115]
    ds_bpermute_b32 v141, v18, v103
    v_mfma_f32_16x16x32_bf16 v[104:107], v[32:35], v[128:131], v[104:107]
    ds_read_b64 v[124:125], v17 offset:1152
    ds_read_b64 v[126:127], v17 offset:1160
    v_mfma_f32_16x16x32_bf16 v[108:111], v[40:43], v[128:131], v[108:111]
    v_mfma_f32_16x16x32_bf16 v[112:115], v[48:51], v[128:131], v[112:115]
    v_mfma_f32_16x16x32_bf16 v[108:111], v[36:39], v[132:135], v[108:111]
    ds_read_b64 v[128:129], v17 offset:1216
    ds_read_b64 v[130:131], v17 offset:1224
    v_mfma_f32_16x16x32_bf16 v[112:115], v[44:47], v[132:135], v[112:115]
    v_mfma_f32_16x16x32_bf16 v[108:111], v[32:35], v[136:139], v[108:111]
    s_waitcnt lgkmcnt(4)
    v_mov_b32 v103, v102
    v_mov_b32 v102, v101
    v_mov_b32 v101, v100
    v_cndmask_b32 v100, v141, v140, s[64:65]
    ds_read_b64 v[132:133], v17 offset:1280
    ds_read_b64 v[134:135], v17 offset:1288
    v_mfma_f32_16x16x32_bf16 v[112:115], v[40:43], v[136:139], v[112:115]
    ds_bpermute_b32 v142, v18, v107
    v_mfma_f32_16x16x32_bf16 v[112:115], v[36:39], v[116:119], v[112:115]
    ds_read_b64 v[136:137], v17 offset:1344
    ds_read_b64 v[138:139], v17 offset:1352
    v_mfma_f32_16x16x32_bf16 v[112:115], v[32:35], v[120:123], v[112:115]
    ds_read_b64 v[116:117], v17 offset:1408
    ds_read_b64 v[118:119], v17 offset:1416
    s_waitcnt lgkmcnt(9)
    v_mfma_f32_16x16x32_bf16 v[96:99], v[36:39], v[124:127], v[96:99]
    ds_read_b64 v[120:121], v17 offset:1472
    ds_read_b64 v[122:123], v17 offset:1480
    v_mfma_f32_16x16x32_bf16 v[100:103], v[44:47], v[124:127], v[100:103]
    s_waitcnt lgkmcnt(6)
    v_mov_b32 v107, v106
    v_mov_b32 v106, v105
    v_mov_b32 v105, v104
    v_cndmask_b32 v104, v142, v141, s[64:65]
    s_nop 1
    v_mfma_f32_16x16x32_bf16 v[104:107], v[52:55], v[124:127], v[104:107]
    ds_bpermute_b32 v143, v18, v111
    s_waitcnt lgkmcnt(0)
    v_mov_b32 v111, v110
    v_mov_b32 v110, v109
    v_mov_b32 v109, v108
    v_cndmask_b32 v108, v143, v142, s[64:65]
    s_nop 1
    v_mfma_f32_16x16x32_bf16 v[108:111], v[60:63], v[124:127], v[108:111]
    ds_bpermute_b32 v147, v18, v115
    s_waitcnt lgkmcnt(0)
    v_mov_b32 v115, v114
    v_mov_b32 v114, v113
    v_mov_b32 v113, v112
    v_cndmask_b32 v112, v147, v143, s[64:65]
    s_nop 1
    v_mfma_f32_16x16x32_bf16 v[112:115], v[68:71], v[124:127], v[112:115]
    v_mfma_f32_16x16x32_bf16 v[96:99], v[32:35], v[128:131], v[96:99]
    ds_read_b64 v[124:125], v17 offset:1536
    ds_read_b64 v[126:127], v17 offset:1544
    v_mfma_f32_16x16x32_bf16 v[100:103], v[40:43], v[128:131], v[100:103]
    v_mfma_f32_16x16x32_bf16 v[104:107], v[48:51], v[128:131], v[104:107]
    v_mfma_f32_16x16x32_bf16 v[108:111], v[56:59], v[128:131], v[108:111]
    v_mfma_f32_16x16x32_bf16 v[112:115], v[64:67], v[128:131], v[112:115]
    v_mfma_f32_16x16x32_bf16 v[100:103], v[36:39], v[132:135], v[100:103]
    ds_read_b64 v[128:129], v17 offset:1600
    ds_read_b64 v[130:131], v17 offset:1608
    v_mfma_f32_16x16x32_bf16 v[104:107], v[44:47], v[132:135], v[104:107]
    ds_bpermute_b32 v140, v18, v99
    v_mfma_f32_16x16x32_bf16 v[108:111], v[52:55], v[132:135], v[108:111]
    v_mfma_f32_16x16x32_bf16 v[112:115], v[60:63], v[132:135], v[112:115]
    v_mfma_f32_16x16x32_bf16 v[100:103], v[32:35], v[136:139], v[100:103]
    ds_read_b64 v[132:133], v17 offset:1664
    ds_read_b64 v[134:135], v17 offset:1672
    v_mfma_f32_16x16x32_bf16 v[104:107], v[40:43], v[136:139], v[104:107]
    v_mfma_f32_16x16x32_bf16 v[108:111], v[48:51], v[136:139], v[108:111]
    v_mfma_f32_16x16x32_bf16 v[112:115], v[56:59], v[136:139], v[112:115]
    s_waitcnt lgkmcnt(2)
    v_mov_b32 v99, v98
    v_mov_b32 v98, v97
    v_mov_b32 v97, v96
    v_cndmask_b32 v96, v140, v19, s[64:65]
    v_mfma_f32_16x16x32_bf16 v[104:107], v[36:39], v[116:119], v[104:107]
    ds_read_b64 v[136:137], v17 offset:1728
    ds_read_b64 v[138:139], v17 offset:1736
    v_mfma_f32_16x16x32_bf16 v[108:111], v[44:47], v[116:119], v[108:111]
    v_mfma_f32_16x16x32_bf16 v[112:115], v[52:55], v[116:119], v[112:115]
    ds_bpermute_b32 v141, v18, v103
    v_mfma_f32_16x16x32_bf16 v[104:107], v[32:35], v[120:123], v[104:107]
    ds_read_b64 v[116:117], v17 offset:0
    ds_read_b64 v[118:119], v17 offset:8
    v_mfma_f32_16x16x32_bf16 v[108:111], v[40:43], v[120:123], v[108:111]
    v_mfma_f32_16x16x32_bf16 v[112:115], v[48:51], v[120:123], v[112:115]
    v_mfma_f32_16x16x32_bf16 v[108:111], v[36:39], v[124:127], v[108:111]
    ds_read_b64 v[120:121], v17 offset:64
    ds_read_b64 v[122:123], v17 offset:72
    v_mfma_f32_16x16x32_bf16 v[112:115], v[44:47], v[124:127], v[112:115]
    v_mfma_f32_16x16x32_bf16 v[108:111], v[32:35], v[128:131], v[108:111]
    s_waitcnt lgkmcnt(4)
    v_mov_b32 v103, v102
    v_mov_b32 v102, v101
    v_mov_b32 v101, v100
    v_cndmask_b32 v100, v141, v140, s[64:65]
    ds_read_b64 v[124:125], v17 offset:128
    ds_read_b64 v[126:127], v17 offset:136
    v_mfma_f32_16x16x32_bf16 v[112:115], v[40:43], v[128:131], v[112:115]
    ds_bpermute_b32 v142, v18, v107
    v_mfma_f32_16x16x32_bf16 v[112:115], v[36:39], v[132:135], v[112:115]
    ds_read_b64 v[128:129], v17 offset:192
    ds_read_b64 v[130:131], v17 offset:200
    v_mfma_f32_16x16x32_bf16 v[112:115], v[32:35], v[136:139], v[112:115]
    ds_read_b64 v[132:133], v17 offset:256
    ds_read_b64 v[134:135], v17 offset:264
    s_waitcnt lgkmcnt(9)
    v_mfma_f32_16x16x32_bf16 v[96:99], v[36:39], v[116:119], v[96:99]
    ds_read_b64 v[136:137], v17 offset:320
    ds_read_b64 v[138:139], v17 offset:328
    v_mfma_f32_16x16x32_bf16 v[100:103], v[44:47], v[116:119], v[100:103]
    s_waitcnt lgkmcnt(6)
    v_mov_b32 v107, v106
    v_mov_b32 v106, v105
    v_mov_b32 v105, v104
    v_cndmask_b32 v104, v142, v141, s[64:65]
    s_nop 1
    v_mfma_f32_16x16x32_bf16 v[104:107], v[52:55], v[116:119], v[104:107]
    ds_bpermute_b32 v143, v18, v111
    s_waitcnt lgkmcnt(0)
    v_mov_b32 v111, v110
    v_mov_b32 v110, v109
    v_mov_b32 v109, v108
    v_cndmask_b32 v108, v143, v142, s[64:65]
    s_nop 1
    v_mfma_f32_16x16x32_bf16 v[108:111], v[60:63], v[116:119], v[108:111]
    ds_bpermute_b32 v146, v18, v115
    s_waitcnt lgkmcnt(0)
    v_mov_b32 v115, v114
    v_mov_b32 v114, v113
    v_mov_b32 v113, v112
    v_cndmask_b32 v112, v146, v143, s[64:65]
    s_nop 1
    v_mfma_f32_16x16x32_bf16 v[112:115], v[68:71], v[116:119], v[112:115]
    v_mfma_f32_16x16x32_bf16 v[96:99], v[32:35], v[120:123], v[96:99]
    ds_read_b64 v[116:117], v17 offset:384
    ds_read_b64 v[118:119], v17 offset:392
    v_mfma_f32_16x16x32_bf16 v[100:103], v[40:43], v[120:123], v[100:103]
    v_mfma_f32_16x16x32_bf16 v[104:107], v[48:51], v[120:123], v[104:107]
    v_mfma_f32_16x16x32_bf16 v[108:111], v[56:59], v[120:123], v[108:111]
    v_mfma_f32_16x16x32_bf16 v[112:115], v[64:67], v[120:123], v[112:115]
    v_mfma_f32_16x16x32_bf16 v[100:103], v[36:39], v[124:127], v[100:103]
    ds_read_b64 v[120:121], v17 offset:448
    ds_read_b64 v[122:123], v17 offset:456
    v_mfma_f32_16x16x32_bf16 v[104:107], v[44:47], v[124:127], v[104:107]
    v_mfma_f32_16x16x32_bf16 v[108:111], v[52:55], v[124:127], v[108:111]
    v_mfma_f32_16x16x32_bf16 v[112:115], v[60:63], v[124:127], v[112:115]
    v_mfma_f32_16x16x32_bf16 v[100:103], v[32:35], v[128:131], v[100:103]
    ds_read_b64 v[124:125], v17 offset:512
    ds_read_b64 v[126:127], v17 offset:520
    v_mfma_f32_16x16x32_bf16 v[104:107], v[40:43], v[128:131], v[104:107]
    v_mfma_f32_16x16x32_bf16 v[108:111], v[48:51], v[128:131], v[108:111]
    v_mfma_f32_16x16x32_bf16 v[112:115], v[56:59], v[128:131], v[112:115]
    v_mfma_f32_16x16x32_bf16 v[104:107], v[36:39], v[132:135], v[104:107]
    ds_read_b64 v[128:129], v17 offset:576
    ds_read_b64 v[130:131], v17 offset:584
    v_mfma_f32_16x16x32_bf16 v[108:111], v[44:47], v[132:135], v[108:111]
    v_mfma_f32_16x16x32_bf16 v[112:115], v[52:55], v[132:135], v[112:115]
    v_mfma_f32_16x16x32_bf16 v[104:107], v[32:35], v[136:139], v[104:107]
    ds_read_b64 v[132:133], v17 offset:3456
    ds_read_b64 v[134:135], v17 offset:3464
    v_mfma_f32_16x16x32_bf16 v[108:111], v[40:43], v[136:139], v[108:111]
    v_mfma_f32_16x16x32_bf16 v[112:115], v[48:51], v[136:139], v[112:115]
    s_waitcnt lgkmcnt(8)
    v_mfma_f32_16x16x32_bf16 v[108:111], v[36:39], v[116:119], v[108:111]
    ds_read_b64 v[136:137], v17 offset:3520
    ds_read_b64 v[138:139], v17 offset:3528
    v_mfma_f32_16x16x32_bf16 v[112:115], v[44:47], v[116:119], v[112:115]
    s_waitcnt lgkmcnt(8)
    v_mfma_f32_16x16x32_bf16 v[108:111], v[32:35], v[120:123], v[108:111]
    ds_read_b64 v[116:117], v17 offset:3584
    ds_read_b64 v[118:119], v17 offset:3592
    v_mfma_f32_16x16x32_bf16 v[112:115], v[40:43], v[120:123], v[112:115]
    s_waitcnt lgkmcnt(8)
    v_mfma_f32_16x16x32_bf16 v[112:115], v[36:39], v[124:127], v[112:115]
    ds_read_b64 v[120:121], v17 offset:3648
    ds_read_b64 v[122:123], v17 offset:3656
    s_waitcnt lgkmcnt(8)
    v_mfma_f32_16x16x32_bf16 v[112:115], v[32:35], v[128:131], v[112:115]
    ds_read_b64 v[124:125], v17 offset:3712
    ds_read_b64 v[126:127], v17 offset:3720
    s_waitcnt lgkmcnt(0)
    s_cmp_eq_u32 s50, 0
    s_cbranch_scc0 EPB0
    v_cvt_pk_bf16_f32 v150, v96, v97
    v_cvt_pk_bf16_f32 v151, v98, v99
    ds_write_b64 v20, v[150:151] offset:0
    v_cvt_pk_bf16_f32 v152, v100, v101
    v_cvt_pk_bf16_f32 v153, v102, v103
    ds_write_b64 v20, v[152:153] offset:640
    v_cvt_pk_bf16_f32 v154, v104, v105
    v_cvt_pk_bf16_f32 v155, v106, v107
    ds_write_b64 v20, v[154:155] offset:1280
    v_cvt_pk_bf16_f32 v156, v108, v109
    v_cvt_pk_bf16_f32 v157, v110, v111
    ds_write_b64 v20, v[156:157] offset:1920
    s_waitcnt lgkmcnt(0)
    v_cvt_pk_bf16_f32 v150, v112, v113
    v_cvt_pk_bf16_f32 v151, v114, v115
    ds_write_b64 v20, v[150:151] offset:2560
    s_branch EPJ0
EPB0:
    s_mov_b32 s71, 524288
SPL15:
    ds_read_b32 v23, v25 offset:28
    s_waitcnt lgkmcnt(0)
    v_readfirstlane_b32 s70, v23
    s_nop 1
    s_cmp_ge_u32 s70, 4
    s_cbranch_scc1 SPD15
    s_sub_u32 s71, s71, 1
    s_cmp_eq_u32 s71, 0
    s_cbranch_scc1 SPD15
    s_nop 7
    s_branch SPL15
SPD15:
    ds_read_u16_d16_hi v150, v22 offset:0
    ds_read_u16_d16_hi v151, v22 offset:1152
    ds_read_u16_d16_hi v152, v22 offset:2304
    ds_read_u16_d16_hi v153, v22 offset:3456
    ds_read_u16_d16_hi v154, v22 offset:128
    ds_read_u16_d16_hi v155, v22 offset:1280
    ds_read_u16_d16_hi v156, v22 offset:2432
    ds_read_u16_d16_hi v157, v22 offset:3584
    s_waitcnt lgkmcnt(4)
    ds_read_u16_d16_hi v158, v22 offset:256
    ds_read_u16_d16_hi v159, v22 offset:1408
    ds_read_u16_d16_hi v160, v22 offset:2560
    ds_read_u16_d16_hi v161, v22 offset:3712
    ds_read_u16_d16_hi v162, v22 offset:384
    ds_read_u16_d16_hi v163, v22 offset:1536
    ds_read_u16_d16_hi v164, v22 offset:2688
    ds_read_u16_d16_hi v165, v22 offset:3840
    s_waitcnt lgkmcnt(4)
    s_waitcnt lgkmcnt(0)
    v_and_b32 v150, 0xffff0000, v150
    v_and_b32 v151, 0xffff0000, v151
    v_and_b32 v152, 0xffff0000, v152
    v_and_b32 v153, 0xffff0000, v153
    v_mul_f32 v150, v150, v96
    v_mul_f32 v151, v151, v97
    v_mul_f32 v152, v152, v98
    v_mul_f32 v153, v153, v99
    v_cvt_pk_bf16_f32 v150, v150, v151
    v_cvt_pk_bf16_f32 v151, v152, v153
    ds_write_b64 v20, v[150:151] offset:0
    v_and_b32 v154, 0xffff0000, v154
    v_and_b32 v155, 0xffff0000, v155
    v_and_b32 v156, 0xffff0000, v156
    v_and_b32 v157, 0xffff0000, v157
    v_mul_f32 v154, v154, v100
    v_mul_f32 v155, v155, v101
    v_mul_f32 v156, v156, v102
    v_mul_f32 v157, v157, v103
    v_cvt_pk_bf16_f32 v154, v154, v155
    v_cvt_pk_bf16_f32 v155, v156, v157
    ds_write_b64 v20, v[154:155] offset:640
    v_and_b32 v158, 0xffff0000, v158
    v_and_b32 v159, 0xffff0000, v159
    v_and_b32 v160, 0xffff0000, v160
    v_and_b32 v161, 0xffff0000, v161
    v_mul_f32 v158, v158, v104
    v_mul_f32 v159, v159, v105
    v_mul_f32 v160, v160, v106
    v_mul_f32 v161, v161, v107
    v_cvt_pk_bf16_f32 v158, v158, v159
    v_cvt_pk_bf16_f32 v159, v160, v161
    ds_write_b64 v20, v[158:159] offset:1280
    v_and_b32 v162, 0xffff0000, v162
    v_and_b32 v163, 0xffff0000, v163
    v_and_b32 v164, 0xffff0000, v164
    v_and_b32 v165, 0xffff0000, v165
    v_mul_f32 v162, v162, v108
    v_mul_f32 v163, v163, v109
    v_mul_f32 v164, v164, v110
    v_mul_f32 v165, v165, v111
    v_cvt_pk_bf16_f32 v162, v162, v163
    v_cvt_pk_bf16_f32 v163, v164, v165
    ds_write_b64 v20, v[162:163] offset:1920
    s_waitcnt lgkmcnt(0)
    ds_read_u16_d16_hi v150, v22 offset:512
    ds_read_u16_d16_hi v151, v22 offset:1664
    ds_read_u16_d16_hi v152, v22 offset:2816
    ds_read_u16_d16_hi v153, v22 offset:3968
    s_waitcnt lgkmcnt(0)
    v_and_b32 v150, 0xffff0000, v150
    v_and_b32 v151, 0xffff0000, v151
    v_and_b32 v152, 0xffff0000, v152
    v_and_b32 v153, 0xffff0000, v153
    v_mul_f32 v150, v150, v112
    v_mul_f32 v151, v151, v113
    v_mul_f32 v152, v152, v114
    v_mul_f32 v153, v153, v115
    v_cvt_pk_bf16_f32 v150, v150, v151
    v_cvt_pk_bf16_f32 v151, v152, v153
    ds_write_b64 v20, v[150:151] offset:2560
    s_waitcnt lgkmcnt(0)
EPJ0:
    s_waitcnt lgkmcnt(0)
    s_mov_b64 exec, 1
    ds_add_u32 v24, v21 offset:40
    s_mov_b64 exec, -1
    v_mfma_f32_16x16x32_bf16 v[96:99], v[76:79], v[132:135], 0
    ds_read_b64 v[128:129], v17 offset:3776
    ds_read_b64 v[130:131], v17 offset:3784
    v_mfma_f32_16x16x32_bf16 v[100:103], v[84:87], v[132:135], 0
    v_mfma_f32_16x16x32_bf16 v[104:107], v[92:95], v[132:135], 0
    v_mfma_f32_16x16x32_bf16 v[96:99], v[72:75], v[136:139], v[96:99]
    ds_read_b64 v[132:133], v17 offset:3840
    ds_read_b64 v[134:135], v17 offset:3848
    v_mfma_f32_16x16x32_bf16 v[100:103], v[80:83], v[136:139], v[100:103]
    v_mfma_f32_16x16x32_bf16 v[104:107], v[88:91], v[136:139], v[104:107]
    v_mfma_f32_16x16x32_bf16 v[96:99], v[68:71], v[116:119], v[96:99]
    ds_read_b64 v[136:137], v17 offset:3904
    ds_read_b64 v[138:139], v17 offset:3912
    v_mfma_f32_16x16x32_bf16 v[100:103], v[76:79], v[116:119], v[100:103]
    v_mfma_f32_16x16x32_bf16 v[104:107], v[84:87], v[116:119], v[104:107]
    v_mfma_f32_16x16x32_bf16 v[96:99], v[64:67], v[120:123], v[96:99]
    ds_read_b64 v[116:117], v17 offset:3968
    ds_read_b64 v[118:119], v17 offset:3976
    v_mfma_f32_16x16x32_bf16 v[100:103], v[72:75], v[120:123], v[100:103]
    v_mfma_f32_16x16x32_bf16 v[104:107], v[80:83], v[120:123], v[104:107]
    v_mfma_f32_16x16x32_bf16 v[96:99], v[60:63], v[124:127], v[96:99]
    ds_read_b64 v[120:121], v17 offset:4032
    ds_read_b64 v[122:123], v17 offset:4040
    v_mfma_f32_16x16x32_bf16 v[100:103], v[68:71], v[124:127], v[100:103]
    v_mfma_f32_16x16x32_bf16 v[104:107], v[76:79], v[124:127], v[104:107]
    s_waitcnt lgkmcnt(8)
    v_mfma_f32_16x16x32_bf16 v[96:99], v[56:59], v[128:131], v[96:99]
    ds_read_b64 v[124:125], v17 offset:4096
    ds_read_b64 v[126:127], v17 offset:4104
    v_mfma_f32_16x16x32_bf16 v[100:103], v[64:67], v[128:131], v[100:103]
    v_mfma_f32_16x16x32_bf16 v[104:107], v[72:75], v[128:131], v[104:107]
    s_waitcnt lgkmcnt(8)
    v_mfma_f32_16x16x32_bf16 v[96:99], v[52:55], v[132:135], v[96:99]
    ds_read_b64 v[128:129], v17 offset:4160
    ds_read_b64 v[130:131], v17 offset:4168
    v_mfma_f32_16x16x32_bf16 v[100:103], v[60:63], v[132:135], v[100:103]
    v_mfma_f32_16x16x32_bf16 v[104:107], v[68:71], v[132:135], v[104:107]
    s_waitcnt lgkmcnt(8)
    v_mfma_f32_16x16x32_bf16 v[96:99], v[48:51], v[136:139], v[96:99]
    ds_read_b64 v[132:133], v17 offset:4224
    ds_read_b64 v[134:135], v17 offset:4232
    v_mfma_f32_16x16x32_bf16 v[100:103], v[56:59], v[136:139], v[100:103]
    v_mfma_f32_16x16x32_bf16 v[104:107], v[64:67], v[136:139], v[104:107]
    s_waitcnt lgkmcnt(8)
    v_mfma_f32_16x16x32_bf16 v[96:99], v[44:47], v[116:119], v[96:99]
    ds_read_b64 v[136:137], v17 offset:4288
    ds_read_b64 v[138:139], v17 offset:4296
    v_mfma_f32_16x16x32_bf16 v[100:103], v[52:55], v[116:119], v[100:103]
    v_mfma_f32_16x16x32_bf16 v[104:107], v[60:63], v[116:119], v[104:107]
    s_waitcnt lgkmcnt(8)
    v_mfma_f32_16x16x32_bf16 v[96:99], v[40:43], v[120:123], v[96:99]
    ds_read_b64 v[116:117], v17 offset:4352
    ds_read_b64 v[118:119], v17 offset:4360
    v_mfma_f32_16x16x32_bf16 v[100:103], v[48:51], v[120:123], v[100:103]
    v_mfma_f32_16x16x32_bf16 v[104:107], v[56:59], v[120:123], v[104:107]
    s_waitcnt lgkmcnt(8)
    v_mfma_f32_16x16x32_bf16 v[96:99], v[36:39], v[124:127], v[96:99]
    ds_read_b64 v[120:121], v17 offset:4416
    ds_read_b64 v[122:123], v17 offset:4424
    v_mfma_f32_16x16x32_bf16 v[100:103], v[44:47], v[124:127], v[100:103]
    v_mfma_f32_16x16x32_bf16 v[104:107], v[52:55], v[124:127], v[104:107]
    s_waitcnt lgkmcnt(8)
    v_mfma_f32_16x16x32_bf16 v[96:99], v[32:35], v[128:131], v[96:99]
    ds_read_b64 v[124:125], v17 offset:2304
    ds_read_b64 v[126:127], v17 offset:2312
    v_mfma_f32_16x16x32_bf16 v[100:103], v[40:43], v[128:131], v[100:103]
    v_mfma_f32_16x16x32_bf16 v[104:107], v[48:51], v[128:131], v[104:107]
    s_waitcnt lgkmcnt(8)
    v_mfma_f32_16x16x32_bf16 v[100:103], v[36:39], v[132:135], v[100:103]
    ds_read_b64 v[128:129], v17 offset:2368
    ds_read_b64 v[130:131], v17 offset:2376
    v_mfma_f32_16x16x32_bf16 v[104:107], v[44:47], v[132:135], v[104:107]
    s_waitcnt lgkmcnt(8)
    v_mfma_f32_16x16x32_bf16 v[100:103], v[32:35], v[136:139], v[100:103]
    ds_read_b64 v[132:133], v17 offset:2432
    ds_read_b64 v[134:135], v17 offset:2440
    v_mfma_f32_16x16x32_bf16 v[104:107], v[40:43], v[136:139], v[104:107]
    ds_bpermute_b32 v140, v18, v99
    s_waitcnt lgkmcnt(9)
    v_mfma_f32_16x16x32_bf16 v[104:107], v[36:39], v[116:119], v[104:107]
    ds_read_b64 v[136:137], v17 offset:2496
    ds_read_b64 v[138:139], v17 offset:2504
    s_waitcnt lgkmcnt(9)
    v_mfma_f32_16x16x32_bf16 v[104:107], v[32:35], v[120:123], v[104:107]
    ds_read_b64 v[116:117], v17 offset:2560
    ds_read_b64 v[118:119], v17 offset:2568
    s_setprio 0
    s_waitcnt lgkmcnt(4)
    v_mov_b32 v99, v98
    v_mov_b32 v98, v97
    v_mov_b32 v97, v96
    v_cndmask_b32 v96, v140, v148, s[64:65]
    s_nop 1
    v_mfma_f32_16x16x32_bf16 v[96:99], v[76:79], v[124:127], v[96:99]
    ds_read_b64 v[120:121], v17 offset:2624
    ds_read_b64 v[122:123], v17 offset:2632
    ds_bpermute_b32 v141, v18, v103
    s_waitcnt lgkmcnt(0)
    v_mov_b32 v103, v102
    v_mov_b32 v102, v101
    v_mov_b32 v101, v100
    v_cndmask_b32 v100, v141, v140, s[64:65]
    s_nop 1
    v_mfma_f32_16x16x32_bf16 v[100:103], v[84:87], v[124:127], v[100:103]
    ds_bpermute_b32 v142, v18, v107
    s_waitcnt lgkmcnt(0)
    v_mov_b32 v107, v106
    v_mov_b32 v106, v105
    v_mov_b32 v105, v104
    v_cndmask_b32 v104, v142, v141, s[64:65]
    s_nop 1
    v_mfma_f32_16x16x32_bf16 v[104:107], v[92:95], v[124:127], v[104:107]
    v_mfma_f32_16x16x32_bf16 v[96:99], v[72:75], v[128:131], v[96:99]
    ds_read_b64 v[124:125], v17 offset:2688
    ds_read_b64 v[126:127], v17 offset:2696
    v_mfma_f32_16x16x32_bf16 v[100:103], v[80:83], v[128:131], v[100:103]
    v_mfma_f32_16x16x32_bf16 v[104:107], v[88:91], v[128:131], v[104:107]
    v_mfma_f32_16x16x32_bf16 v[96:99], v[68:71], v[132:135], v[96:99]
    ds_read_b64 v[128:129], v17 offset:2752
    ds_read_b64 v[130:131], v17 offset:2760
    v_mfma_f32_16x16x32_bf16 v[100:103], v[76:79], v[132:135], v[100:103]
    v_mfma_f32_16x16x32_bf16 v[104:107], v[84:87], v[132:135], v[104:107]
    v_mfma_f32_16x16x32_bf16 v[96:99], v[64:67], v[136:139], v[96:99]
    ds_read_b64 v[132:133], v17 offset:2816
    ds_read_b64 v[134:135], v17 offset:2824
    v_mfma_f32_16x16x32_bf16 v[100:103], v[72:75], v[136:139], v[100:103]
    v_mfma_f32_16x16x32_bf16 v[104:107], v[80:83], v[136:139], v[104:107]
    v_mfma_f32_16x16x32_bf16 v[96:99], v[60:63], v[116:119], v[96:99]
    ds_read_b64 v[136:137], v17 offset:2880
    ds_read_b64 v[138:139], v17 offset:2888
    v_mfma_f32_16x16x32_bf16 v[100:103], v[68:71], v[116:119], v[100:103]
    v_mfma_f32_16x16x32_bf16 v[104:107], v[76:79], v[116:119], v[104:107]
    v_mfma_f32_16x16x32_bf16 v[96:99], v[56:59], v[120:123], v[96:99]
    ds_read_b64 v[116:117], v17 offset:2944
    ds_read_b64 v[118:119], v17 offset:2952
    v_mfma_f32_16x16x32_bf16 v[100:103], v[64:67], v[120:123], v[100:103]
    v_mfma_f32_16x16x32_bf16 v[104:107], v[72:75], v[120:123], v[104:107]
    s_waitcnt lgkmcnt(8)
    v_mfma_f32_16x16x32_bf16 v[96:99], v[52:55], v[124:127], v[96:99]
    ds_read_b64 v[120:121], v17 offset:3008
    ds_read_b64 v[122:123], v17 offset:3016
    v_mfma_f32_16x16x32_bf16 v[100:103], v[60:63], v[124:127], v[100:103]
    v_mfma_f32_16x16x32_bf16 v[104:107], v[68:71], v[124:127], v[104:107]
    s_waitcnt lgkmcnt(8)
    v_mfma_f32_16x16x32_bf16 v[96:99], v[48:51], v[128:131], v[96:99]
    ds_read_b64 v[124:125], v17 offset:3072
    ds_read_b64 v[126:127], v17 offset:3080
    v_mfma_f32_16x16x32_bf16 v[100:103], v[56:59], v[128:131], v[100:103]
    v_mfma_f32_16x16x32_bf16 v[104:107], v[64:67], v[128:131], v[104:107]
    s_waitcnt lgkmcnt(8)
    v_mfma_f32_16x16x32_bf16 v[96:99], v[44:47], v[132:135], v[96:99]
    ds_read_b64 v[128:129], v17 offset:3136
    ds_read_b64 v[130:131], v17 offset:3144
    v_mfma_f32_16x16x32_bf16 v[100:103], v[52:55], v[132:135], v[100:103]
    v_mfma_f32_16x16x32_bf16 v[104:107], v[60:63], v[132:135], v[104:107]
    s_waitcnt lgkmcnt(8)
    v_mfma_f32_16x16x32_bf16 v[96:99], v[40:43], v[136:139], v[96:99]
    ds_read_b64 v[132:133], v17 offset:3200
    ds_read_b64 v[134:135], v17 offset:3208
    v_mfma_f32_16x16x32_bf16 v[100:103], v[48:51], v[136:139], v[100:103]
    v_mfma_f32_16x16x32_bf16 v[104:107], v[56:59], v[136:139], v[104:107]
    s_waitcnt lgkmcnt(8)
    v_mfma_f32_16x16x32_bf16 v[96:99], v[36:39], v[116:119], v[96:99]
    ds_read_b64 v[136:137], v17 offset:3264
    ds_read_b64 v[138:139], v17 offset:3272
    v_mfma_f32_16x16x32_bf16 v[100:103], v[44:47], v[116:119], v[100:103]
    v_mfma_f32_16x16x32_bf16 v[104:107], v[52:55], v[116:119], v[104:107]
    s_waitcnt lgkmcnt(8)
    v_mfma_f32_16x16x32_bf16 v[96:99], v[32:35], v[120:123], v[96:99]
    ds_read_b64 v[116:117], v17 offset:1152
    ds_read_b64 v[118:119], v17 offset:1160
    v_mfma_f32_16x16x32_bf16 v[100:103], v[40:43], v[120:123], v[100:103]
    v_mfma_f32_16x16x32_bf16 v[104:107], v[48:51], v[120:123], v[104:107]
    s_waitcnt lgkmcnt(8)
    v_mfma_f32_16x16x32_bf16 v[100:103], v[36:39], v[124:127], v[100:103]
    ds_read_b64 v[120:121], v17 offset:1216
    ds_read_b64 v[122:123], v17 offset:1224
    v_mfma_f32_16x16x32_bf16 v[104:107], v[44:47], v[124:127], v[104:107]
    s_waitcnt lgkmcnt(8)
    v_mfma_f32_16x16x32_bf16 v[100:103], v[32:35], v[128:131], v[100:103]
    ds_read_b64 v[124:125], v17 offset:1280
    ds_read_b64 v[126:127], v17 offset:1288
    v_mfma_f32_16x16x32_bf16 v[104:107], v[40:43], v[128:131], v[104:107]
    ds_bpermute_b32 v140, v18, v99
    s_waitcnt lgkmcnt(9)
    v_mfma_f32_16x16x32_bf16 v[104:107], v[36:39], v[132:135], v[104:107]
    ds_read_b64 v[128:129], v17 offset:1344
    ds_read_b64 v[130:131], v17 offset:1352
    s_waitcnt lgkmcnt(9)
    v_mfma_f32_16x16x32_bf16 v[104:107], v[32:35], v[136:139], v[104:107]
    ds_read_b64 v[132:133], v17 offset:1408
    ds_read_b64 v[134:135], v17 offset:1416
    s_waitcnt lgkmcnt(4)
    v_mov_b32 v99, v98
    v_mov_b32 v98, v97
    v_mov_b32 v97, v96
    v_cndmask_b32 v96, v140, v147, s[64:65]
    s_nop 1
    v_mfma_f32_16x16x32_bf16 v[96:99], v[76:79], v[116:119], v[96:99]
    ds_read_b64 v[136:137], v17 offset:1472
    ds_read_b64 v[138:139], v17 offset:1480
    ds_bpermute_b32 v141, v18, v103
    s_waitcnt lgkmcnt(0)
    v_mov_b32 v103, v102
    v_mov_b32 v102, v101
    v_mov_b32 v101, v100
    v_cndmask_b32 v100, v141, v140, s[64:65]
    s_nop 1
    v_mfma_f32_16x16x32_bf16 v[100:103], v[84:87], v[116:119], v[100:103]
    ds_bpermute_b32 v142, v18, v107
    s_waitcnt lgkmcnt(0)
    v_mov_b32 v107, v106
    v_mov_b32 v106, v105
    v_mov_b32 v105, v104
    v_cndmask_b32 v104, v142, v141, s[64:65]
    s_nop 1
    v_mfma_f32_16x16x32_bf16 v[104:107], v[92:95], v[116:119], v[104:107]
    v_mfma_f32_16x16x32_bf16 v[96:99], v[72:75], v[120:123], v[96:99]
    ds_read_b64 v[116:117], v17 offset:1536
    ds_read_b64 v[118:119], v17 offset:1544
    v_mfma_f32_16x16x32_bf16 v[100:103], v[80:83], v[120:123], v[100:103]
    v_mfma_f32_16x16x32_bf16 v[104:107], v[88:91], v[120:123], v[104:107]
    v_mfma_f32_16x16x32_bf16 v[96:99], v[68:71], v[124:127], v[96:99]
    ds_read_b64 v[120:121], v17 offset:1600
    ds_read_b64 v[122:123], v17 offset:1608
    v_mfma_f32_16x16x32_bf16 v[100:103], v[76:79], v[124:127], v[100:103]
    v_mfma_f32_16x16x32_bf16 v[104:107], v[84:87], v[124:127], v[104:107]
    v_mfma_f32_16x16x32_bf16 v[96:99], v[64:67], v[128:131], v[96:99]
    ds_read_b64 v[124:125], v17 offset:1664
    ds_read_b64 v[126:127], v17 offset:1672
    v_mfma_f32_16x16x32_bf16 v[100:103], v[72:75], v[128:131], v[100:103]
    v_mfma_f32_16x16x32_bf16 v[104:107], v[80:83], v[128:131], v[104:107]
    v_mfma_f32_16x16x32_bf16 v[96:99], v[60:63], v[132:135], v[96:99]
    ds_read_b64 v[128:129], v17 offset:1728
    ds_read_b64 v[130:131], v17 offset:1736
    v_mfma_f32_16x16x32_bf16 v[100:103], v[68:71], v[132:135], v[100:103]
    v_mfma_f32_16x16x32_bf16 v[104:107], v[76:79], v[132:135], v[104:107]
    v_mfma_f32_16x16x32_bf16 v[96:99], v[56:59], v[136:139], v[96:99]
    ds_read_b64 v[132:133], v17 offset:1792
    ds_read_b64 v[134:135], v17 offset:1800
    v_mfma_f32_16x16x32_bf16 v[100:103], v[64:67], v[136:139], v[100:103]
    v_mfma_f32_16x16x32_bf16 v[104:107], v[72:75], v[136:139], v[104:107]
    s_waitcnt lgkmcnt(8)
    v_mfma_f32_16x16x32_bf16 v[96:99], v[52:55], v[116:119], v[96:99]
    ds_read_b64 v[136:137], v17 offset:1856
    ds_read_b64 v[138:139], v17 offset:1864
    v_mfma_f32_16x16x32_bf16 v[100:103], v[60:63], v[116:119], v[100:103]
    v_mfma_f32_16x16x32_bf16 v[104:107], v[68:71], v[116:119], v[104:107]
    s_waitcnt lgkmcnt(8)
    v_mfma_f32_16x16x32_bf16 v[96:99], v[48:51], v[120:123], v[96:99]
    ds_read_b64 v[116:117], v17 offset:1920
    ds_read_b64 v[118:119], v17 offset:1928
    v_mfma_f32_16x16x32_bf16 v[100:103], v[56:59], v[120:123], v[100:103]
    v_mfma_f32_16x16x32_bf16 v[104:107], v[64:67], v[120:123], v[104:107]
    s_waitcnt lgkmcnt(8)
    v_mfma_f32_16x16x32_bf16 v[96:99], v[44:47], v[124:127], v[96:99]
    ds_read_b64 v[120:121], v17 offset:1984
    ds_read_b64 v[122:123], v17 offset:1992
    v_mfma_f32_16x16x32_bf16 v[100:103], v[52:55], v[124:127], v[100:103]
    v_mfma_f32_16x16x32_bf16 v[104:107], v[60:63], v[124:127], v[104:107]
    s_waitcnt lgkmcnt(8)
    v_mfma_f32_16x16x32_bf16 v[96:99], v[40:43], v[128:131], v[96:99]
    ds_read_b64 v[124:125], v17 offset:2048
    ds_read_b64 v[126:127], v17 offset:2056
    v_mfma_f32_16x16x32_bf16 v[100:103], v[48:51], v[128:131], v[100:103]
    v_mfma_f32_16x16x32_bf16 v[104:107], v[56:59], v[128:131], v[104:107]
    s_waitcnt lgkmcnt(8)
    v_mfma_f32_16x16x32_bf16 v[96:99], v[36:39], v[132:135], v[96:99]
    ds_read_b64 v[128:129], v17 offset:2112
    ds_read_b64 v[130:131], v17 offset:2120
    v_mfma_f32_16x16x32_bf16 v[100:103], v[44:47], v[132:135], v[100:103]
    v_mfma_f32_16x16x32_bf16 v[104:107], v[52:55], v[132:135], v[104:107]
    s_waitcnt lgkmcnt(8)
    v_mfma_f32_16x16x32_bf16 v[96:99], v[32:35], v[136:139], v[96:99]
    ds_read_b64 v[132:133], v17 offset:0
    ds_read_b64 v[134:135], v17 offset:8
    v_mfma_f32_16x16x32_bf16 v[100:103], v[40:43], v[136:139], v[100:103]
    v_mfma_f32_16x16x32_bf16 v[104:107], v[48:51], v[136:139], v[104:107]
    s_waitcnt lgkmcnt(8)
    v_mfma_f32_16x16x32_bf16 v[100:103], v[36:39], v[116:119], v[100:103]
    ds_read_b64 v[136:137], v17 offset:64
    ds_read_b64 v[138:139], v17 offset:72
    v_mfma_f32_16x16x32_bf16 v[104:107], v[44:47], v[116:119], v[104:107]
    s_waitcnt lgkmcnt(8)
    v_mfma_f32_16x16x32_bf16 v[100:103], v[32:35], v[120:123], v[100:103]
    ds_read_b64 v[116:117], v17 offset:128
    ds_read_b64 v[118:119], v17 offset:136
    v_mfma_f32_16x16x32_bf16 v[104:107], v[40:43], v[120:123], v[104:107]
    ds_bpermute_b32 v140, v18, v99
    s_waitcnt lgkmcnt(9)
    v_mfma_f32_16x16x32_bf16 v[104:107], v[36:39], v[124:127], v[104:107]
    ds_read_b64 v[120:121], v17 offset:192
    ds_read_b64 v[122:123], v17 offset:200
    s_waitcnt lgkmcnt(9)
    v_mfma_f32_16x16x32_bf16 v[104:107], v[32:35], v[128:131], v[104:107]
    ds_read_b64 v[124:125], v17 offset:256
    ds_read_b64 v[126:127], v17 offset:264
    s_waitcnt lgkmcnt(4)
    v_mov_b32 v99, v98
    v_mov_b32 v98, v97
    v_mov_b32 v97, v96
    v_cndmask_b32 v96, v140, v146, s[64:65]
    s_nop 1
    v_mfma_f32_16x16x32_bf16 v[96:99], v[76:79], v[132:135], v[96:99]
    ds_read_b64 v[128:129], v17 offset:320
    ds_read_b64 v[130:131], v17 offset:328
    ds_bpermute_b32 v141, v18, v103
    s_waitcnt lgkmcnt(0)
    v_mov_b32 v103, v102
    v_mov_b32 v102, v101
    v_mov_b32 v101, v100
    v_cndmask_b32 v100, v141, v140, s[64:65]
    s_nop 1
    v_mfma_f32_16x16x32_bf16 v[100:103], v[84:87], v[132:135], v[100:103]
    ds_bpermute_b32 v142, v18, v107
    s_waitcnt lgkmcnt(0)
    v_mov_b32 v107, v106
    v_mov_b32 v106, v105
    v_mov_b32 v105, v104
    v_cndmask_b32 v104, v142, v141, s[64:65]
    s_nop 1
    v_mfma_f32_16x16x32_bf16 v[104:107], v[92:95], v[132:135], v[104:107]
    v_mfma_f32_16x16x32_bf16 v[96:99], v[72:75], v[136:139], v[96:99]
    ds_read_b64 v[132:133], v17 offset:384
    ds_read_b64 v[134:135], v17 offset:392
    v_mfma_f32_16x16x32_bf16 v[100:103], v[80:83], v[136:139], v[100:103]
    v_mfma_f32_16x16x32_bf16 v[104:107], v[88:91], v[136:139], v[104:107]
    v_mfma_f32_16x16x32_bf16 v[96:99], v[68:71], v[116:119], v[96:99]
    ds_read_b64 v[136:137], v17 offset:448
    ds_read_b64 v[138:139], v17 offset:456
    v_mfma_f32_16x16x32_bf16 v[100:103], v[76:79], v[116:119], v[100:103]
    v_mfma_f32_16x16x32_bf16 v[104:107], v[84:87], v[116:119], v[104:107]
    v_mfma_f32_16x16x32_bf16 v[96:99], v[64:67], v[120:123], v[96:99]
    ds_read_b64 v[116:117], v17 offset:512
    ds_read_b64 v[118:119], v17 offset:520
    v_mfma_f32_16x16x32_bf16 v[100:103], v[72:75], v[120:123], v[100:103]
    v_mfma_f32_16x16x32_bf16 v[104:107], v[80:83], v[120:123], v[104:107]
    v_mfma_f32_16x16x32_bf16 v[96:99], v[60:63], v[124:127], v[96:99]
    ds_read_b64 v[120:121], v17 offset:576
    ds_read_b64 v[122:123], v17 offset:584
    v_mfma_f32_16x16x32_bf16 v[100:103], v[68:71], v[124:127], v[100:103]
    v_mfma_f32_16x16x32_bf16 v[104:107], v[76:79], v[124:127], v[104:107]
    v_mfma_f32_16x16x32_bf16 v[96:99], v[56:59], v[128:131], v[96:99]
    ds_read_b64 v[124:125], v17 offset:640
    ds_read_b64 v[126:127], v17 offset:648
    v_mfma_f32_16x16x32_bf16 v[100:103], v[64:67], v[128:131], v[100:103]
    v_mfma_f32_16x16x32_bf16 v[104:107], v[72:75], v[128:131], v[104:107]
    s_waitcnt lgkmcnt(8)
    v_mfma_f32_16x16x32_bf16 v[96:99], v[52:55], v[132:135], v[96:99]
    ds_read_b64 v[128:129], v17 offset:704
    ds_read_b64 v[130:131], v17 offset:712
    v_mfma_f32_16x16x32_bf16 v[100:103], v[60:63], v[132:135], v[100:103]
    v_mfma_f32_16x16x32_bf16 v[104:107], v[68:71], v[132:135], v[104:107]
    s_waitcnt lgkmcnt(8)
    v_mfma_f32_16x16x32_bf16 v[96:99], v[48:51], v[136:139], v[96:99]
    ds_read_b64 v[132:133], v17 offset:768
    ds_read_b64 v[134:135], v17 offset:776
    v_mfma_f32_16x16x32_bf16 v[100:103], v[56:59], v[136:139], v[100:103]
    v_mfma_f32_16x16x32_bf16 v[104:107], v[64:67], v[136:139], v[104:107]
    s_waitcnt lgkmcnt(8)
    v_mfma_f32_16x16x32_bf16 v[96:99], v[44:47], v[116:119], v[96:99]
    ds_read_b64 v[136:137], v17 offset:832
    ds_read_b64 v[138:139], v17 offset:840
    v_mfma_f32_16x16x32_bf16 v[100:103], v[52:55], v[116:119], v[100:103]
    v_mfma_f32_16x16x32_bf16 v[104:107], v[60:63], v[116:119], v[104:107]
    s_waitcnt lgkmcnt(8)
    v_mfma_f32_16x16x32_bf16 v[96:99], v[40:43], v[120:123], v[96:99]
    ds_read_b64 v[116:117], v17 offset:896
    ds_read_b64 v[118:119], v17 offset:904
    v_mfma_f32_16x16x32_bf16 v[100:103], v[48:51], v[120:123], v[100:103]
    v_mfma_f32_16x16x32_bf16 v[104:107], v[56:59], v[120:123], v[104:107]
    s_waitcnt lgkmcnt(8)
    v_mfma_f32_16x16x32_bf16 v[96:99], v[36:39], v[124:127], v[96:99]
    ds_read_b64 v[120:121], v17 offset:960
    ds_read_b64 v[122:123], v17 offset:968
    v_mfma_f32_16x16x32_bf16 v[100:103], v[44:47], v[124:127], v[100:103]
    v_mfma_f32_16x16x32_bf16 v[104:107], v[52:55], v[124:127], v[104:107]
    s_waitcnt lgkmcnt(8)
    v_mfma_f32_16x16x32_bf16 v[96:99], v[32:35], v[128:131], v[96:99]
    v_mfma_f32_16x16x32_bf16 v[100:103], v[40:43], v[128:131], v[100:103]
    v_mfma_f32_16x16x32_bf16 v[104:107], v[48:51], v[128:131], v[104:107]
    s_waitcnt lgkmcnt(6)
    v_mfma_f32_16x16x32_bf16 v[100:103], v[36:39], v[132:135], v[100:103]
    v_mfma_f32_16x16x32_bf16 v[104:107], v[44:47], v[132:135], v[104:107]
    s_waitcnt lgkmcnt(4)
    v_mfma_f32_16x16x32_bf16 v[100:103], v[32:35], v[136:139], v[100:103]
    v_mfma_f32_16x16x32_bf16 v[104:107], v[40:43], v[136:139], v[104:107]
    s_waitcnt lgkmcnt(2)
    v_mfma_f32_16x16x32_bf16 v[104:107], v[36:39], v[116:119], v[104:107]
    s_waitcnt lgkmcnt(0)
    v_mfma_f32_16x16x32_bf16 v[104:107], v[32:35], v[120:123], v[104:107]
    s_waitcnt lgkmcnt(0)
    s_cmp_eq_u32 s50, 0
    s_cbranch_scc0 EPB1
    v_cvt_pk_bf16_f32 v150, v96, v97
    v_cvt_pk_bf16_f32 v151, v98, v99
    ds_write_b64 v20, v[150:151] offset:3200
    v_cvt_pk_bf16_f32 v152, v100, v101
    v_cvt_pk_bf16_f32 v153, v102, v103
    ds_write_b64 v20, v[152:153] offset:3840
    v_cvt_pk_bf16_f32 v154, v104, v105
    v_cvt_pk_bf16_f32 v155, v106, v107
    ds_write_b64 v20, v[154:155] offset:4480
    s_branch EPJ1
EPB1:
    ds_read_u16_d16_hi v150, v22 offset:640
    ds_read_u16_d16_hi v151, v22 offset:1792
    ds_read_u16_d16_hi v152, v22 offset:2944
    ds_read_u16_d16_hi v153, v22 offset:4096
    ds_read_u16_d16_hi v154, v22 offset:768
    ds_read_u16_d16_hi v155, v22 offset:1920
    ds_read_u16_d16_hi v156, v22 offset:3072
    ds_read_u16_d16_hi v157, v22 offset:4224
    s_waitcnt lgkmcnt(4)
    ds_read_u16_d16_hi v158, v22 offset:896
    ds_read_u16_d16_hi v159, v22 offset:2048
    ds_read_u16_d16_hi v160, v22 offset:3200
    ds_read_u16_d16_hi v161, v22 offset:4352
    s_waitcnt lgkmcnt(0)
    v_and_b32 v150, 0xffff0000, v150
    v_and_b32 v151, 0xffff0000, v151
    v_and_b32 v152, 0xffff0000, v152
    v_and_b32 v153, 0xffff0000, v153
    v_mul_f32 v150, v150, v96
    v_mul_f32 v151, v151, v97
    v_mul_f32 v152, v152, v98
    v_mul_f32 v153, v153, v99
    v_cvt_pk_bf16_f32 v150, v150, v151
    v_cvt_pk_bf16_f32 v151, v152, v153
    ds_write_b64 v20, v[150:151] offset:3200
    v_and_b32 v154, 0xffff0000, v154
    v_and_b32 v155, 0xffff0000, v155
    v_and_b32 v156, 0xffff0000, v156
    v_and_b32 v157, 0xffff0000, v157
    v_mul_f32 v154, v154, v100
    v_mul_f32 v155, v155, v101
    v_mul_f32 v156, v156, v102
    v_mul_f32 v157, v157, v103
    v_cvt_pk_bf16_f32 v154, v154, v155
    v_cvt_pk_bf16_f32 v155, v156, v157
    ds_write_b64 v20, v[154:155] offset:3840
    v_and_b32 v158, 0xffff0000, v158
    v_and_b32 v159, 0xffff0000, v159
    v_and_b32 v160, 0xffff0000, v160
    v_and_b32 v161, 0xffff0000, v161
    v_mul_f32 v158, v158, v104
    v_mul_f32 v159, v159, v105
    v_mul_f32 v160, v160, v106
    v_mul_f32 v161, v161, v107
    v_cvt_pk_bf16_f32 v158, v158, v159
    v_cvt_pk_bf16_f32 v159, v160, v161
    ds_write_b64 v20, v[158:159] offset:4480
    s_waitcnt lgkmcnt(0)
EPJ1:
    s_waitcnt lgkmcnt(0)
    s_mov_b64 exec, 1
    ds_add_u32 v24, v21 offset:44
    s_mov_b64 exec, -1
KFIN:
KEND:
    s_endpgm
.section .rodata,"a"
.p2align 6
.amdhsa_kernel gated_mix__ssm_conv_s4d__ssm_conv_h3__prompt_kernel
  .amdhsa_next_free_vgpr 168
  .amdhsa_next_free_sgpr 102
  .amdhsa_accum_offset 168
  .amdhsa_group_segment_fixed_size 0
  .amdhsa_kernarg_size 136
  .amdhsa_user_sgpr_count 2
  .amdhsa_user_sgpr_kernarg_segment_ptr 1
  .amdhsa_system_sgpr_workgroup_id_x 1
  .amdhsa_ieee_mode 0
.end_amdhsa_kernel
```
